```python
import torch

def _softmax(x, axis=-1):
    return torch.softmax(x, dim=axis)
def _gelu(x):
    return torch.nn.functional.gelu(x, approximate="tanh")
def _silu(x):
    return torch.nn.functional.silu(x)
def _sigmoid(x):
    return torch.sigmoid(x)
def _layernorm(x, axis=-1, eps=1e-5):
    m = x.mean(dim=axis, keepdim=True)
    v = x.var(dim=axis, keepdim=True, unbiased=False)
    return (x - m) / torch.sqrt(v + eps)
def _scatter_add(tgt, idx, src, axis=0):
    return tgt.clone().index_add_(axis, idx, src)
def _segment_sum(src, seg, n):
    out = torch.zeros((n,) + src.shape[1:], dtype=src.dtype)
    return out.index_add_(0, seg, src)
def _pad(x, pw):
    flat = tuple(v for pair in reversed(pw) for v in pair)
    return torch.nn.functional.pad(x, flat)

kernel_name = 'standalone__dcn_v2_cross__recsys'

def setup_inputs():

    _w = (lambda a: (lambda t: t.to(torch.bfloat16) if t.is_floating_point() else t)(torch.as_tensor(a)))
    B, F, D, L = 4096, 100, 32, 3
    Din = min(F * D, 1024)
    return {
        "x0": _w((lambda *s: torch.randn(*s, dtype=torch.bfloat16) * 0.05)(B, Din)),
        "ws": _w((lambda *s: torch.randn(*s, dtype=torch.bfloat16) * 0.05)(L, Din, Din)),
        "bs": _w((lambda *s: torch.randn(*s, dtype=torch.bfloat16) * 0.05)(L, Din)),
    }

def reference(x0, ws, bs):
    x = x0
    for l in range(ws.shape[0]):
        x = x0 * (x @ ws[l] + bs[l]) + x
    return x
```

```asm
; @launch grid=(256,1,1) block=(256,1,1) lds=163840
.amdgcn_target "amdgcn-amd-amdhsa--gfx950"
.text
.globl standalone__dcn_v2_cross__recsys_kernel
.p2align 8
.type standalone__dcn_v2_cross__recsys_kernel,@function
standalone__dcn_v2_cross__recsys_kernel:
    s_cmp_ge_u32 s2, 256
    s_cbranch_scc1 L_end
    s_load_dwordx4 s[44:47], s[0:1], 0
    s_load_dwordx4 s[48:51], s[0:1], 16
    s_load_dwordx4 s[64:67], s[0:1], 32
    v_lshrrev_b32 v46, 6, v0
    v_and_b32 v0, 63, v0
    s_and_b32 s68, s2, 7
    s_lshr_b32 s69, s2, 3
    v_readfirstlane_b32 s30, v46
    s_and_b32 s29, s69, 7
    s_lshr_b32 s69, s69, 3
    s_lshl_b32 s68, s68, 2
    s_add_u32 s28, s68, s69
    s_mov_b32 s58, 0xffff0000
    s_mov_b32 s74, 200000
    s_lshl_b32 s42, s30, 13
    s_lshl_b32 s68, s28, 7
    s_lshl_b32 s69, s30, 5
    s_add_u32 s68, s68, s69
    s_lshl_b32 s52, s68, 11
    s_lshl_b32 s56, s29, 8
    s_add_u32 s57, s52, s56
    s_lshl_b32 s68, s28, 2
    s_add_u32 s68, s68, s30
    s_lshl_b32 s69, s68, 16
    s_add_u32 s70, s29, 0
    s_and_b32 s70, s70, 7
    s_lshl_b32 s70, s70, 13
    s_add_u32 s34, s69, s70
    s_add_u32 s70, s29, 1
    s_and_b32 s70, s70, 7
    s_lshl_b32 s70, s70, 13
    s_add_u32 s35, s69, s70
    s_add_u32 s70, s29, 2
    s_and_b32 s70, s70, 7
    s_lshl_b32 s70, s70, 13
    s_add_u32 s36, s69, s70
    s_add_u32 s70, s29, 3
    s_and_b32 s70, s70, 7
    s_lshl_b32 s70, s70, 13
    s_add_u32 s37, s69, s70
    s_add_u32 s70, s29, 4
    s_and_b32 s70, s70, 7
    s_lshl_b32 s70, s70, 13
    s_add_u32 s38, s69, s70
    s_add_u32 s70, s29, 5
    s_and_b32 s70, s70, 7
    s_lshl_b32 s70, s70, 13
    s_add_u32 s39, s69, s70
    s_add_u32 s70, s29, 6
    s_and_b32 s70, s70, 7
    s_lshl_b32 s70, s70, 13
    s_add_u32 s40, s69, s70
    s_add_u32 s70, s29, 7
    s_and_b32 s70, s70, 7
    s_lshl_b32 s70, s70, 13
    s_add_u32 s41, s69, s70
    s_lshl_b32 s70, s30, 1
    s_add_u32 s70, s70, 0
    s_add_u32 s70, s70, s29
    s_and_b32 s70, s70, 7
    s_lshl_b32 s70, s70, 18
    s_add_u32 s32, s70, s56
    s_lshl_b32 s70, s30, 1
    s_add_u32 s70, s70, 1
    s_add_u32 s70, s70, s29
    s_and_b32 s70, s70, 7
    s_lshl_b32 s70, s70, 18
    s_add_u32 s33, s70, s56
    s_lshr_b32 s71, s30, 1
    s_add_u32 s71, s71, s29
    s_lshl_b32 s73, s30, 1
    s_and_b32 s73, s73, 3
    s_lshl_b32 s73, s73, 16
    s_add_u32 s73, s73, s56
    s_add_u32 s70, s71, 0
    s_and_b32 s70, s70, 7
    s_lshl_b32 s70, s70, 18
    s_add_u32 s82, s70, s73
    s_add_u32 s70, s71, 2
    s_and_b32 s70, s70, 7
    s_lshl_b32 s70, s70, 18
    s_add_u32 s83, s70, s73
    s_add_u32 s70, s71, 4
    s_and_b32 s70, s70, 7
    s_lshl_b32 s70, s70, 18
    s_add_u32 s84, s70, s73
    s_add_u32 s70, s71, 6
    s_and_b32 s70, s70, 7
    s_lshl_b32 s70, s70, 18
    s_add_u32 s85, s70, s73
    s_add_u32 s70, s29, 0
    s_and_b32 s70, s70, 7
    s_lshl_b32 s70, s70, 8
    s_add_u32 s86, s70, s52
    s_add_u32 s70, s29, 1
    s_and_b32 s70, s70, 7
    s_lshl_b32 s70, s70, 8
    s_add_u32 s87, s70, s52
    s_add_u32 s70, s29, 2
    s_and_b32 s70, s70, 7
    s_lshl_b32 s70, s70, 8
    s_add_u32 s88, s70, s52
    s_add_u32 s70, s29, 3
    s_and_b32 s70, s70, 7
    s_lshl_b32 s70, s70, 8
    s_add_u32 s89, s70, s52
    s_add_u32 s70, s29, 4
    s_and_b32 s70, s70, 7
    s_lshl_b32 s70, s70, 8
    s_add_u32 s90, s70, s52
    s_add_u32 s70, s29, 5
    s_and_b32 s70, s70, 7
    s_lshl_b32 s70, s70, 8
    s_add_u32 s91, s70, s52
    s_add_u32 s70, s29, 6
    s_and_b32 s70, s70, 7
    s_lshl_b32 s70, s70, 8
    s_add_u32 s92, s70, s52
    s_add_u32 s70, s29, 7
    s_and_b32 s70, s70, 7
    s_lshl_b32 s70, s70, 8
    s_add_u32 s93, s70, s52
    s_lshl_b32 s72, s68, 7
    s_lshl_b32 s73, s29, 2
    s_add_u32 s73, s73, s72
    v_lshlrev_b32 v1, 4, v0
    v_add_u32 v2, 4096, v1
    v_lshrrev_b32 v46, 5, v0
    v_and_b32 v47, 31, v0
    v_lshrrev_b32 v48, 2, v0
    v_and_b32 v48, 3, v48
    v_and_b32 v49, 3, v0
    v_lshrrev_b32 v50, 4, v0
    v_and_b32 v50, 1, v50
    v_lshlrev_b32 v13, 5, v0
    v_add_u32 v13, s73, v13
    v_mov_b32 v51, 0x7ffffff0
    v_cmp_gt_u32 vcc, 4, v0
    s_nop 1
    v_cndmask_b32 v52, v51, v13, vcc
    v_cmp_gt_u32 vcc, 1, v0
    s_nop 1
    v_cndmask_b32 v13, v51, v13, vcc
    v_mov_b32 v26, v52
    v_and_b32 v14, 7, v0
    v_lshlrev_b32 v14, 2, v14
    v_add_u32 v14, s72, v14
    s_lshl_b32 s70, s28, 2
    v_mov_b32 v54, s70
    s_lshl_b32 s71, s30, 6
    v_or_b32 v53, s71, v0
    v_cmp_eq_u32 vcc, 0, v53
    s_nop 1
    v_cndmask_b32 v54, v51, v54, vcc
    s_getreg_b32 s75, hwreg(HW_REG_XCC_ID)
    s_and_b32 s75, s75, 7
    s_lshl_b32 s75, s75, 2
    s_lshl_b32 s70, 1, s75
    v_mov_b32 v55, s70
    s_lshl_b32 s75, 8, s75
    v_lshrrev_b32 v51, 3, v0
    v_and_b32 v52, 7, v0
    v_lshrrev_b32 v53, 4, v0
    v_and_b32 v53, 1, v53
    v_lshlrev_b32 v53, 2, v53
    v_xor_b32 v52, v52, v53
    v_lshlrev_b32 v52, 4, v52
    v_lshlrev_b32 v51, 11, v51
    v_add_u32 v9, v51, v52
    v_add_u32 v10, 15360, v9
    v_add_u32 v11, 30720, v9
    v_add_u32 v12, 46080, v9
    v_lshrrev_b32 v51, 1, v48
    v_lshlrev_b32 v51, 6, v51
    v_lshlrev_b32 v52, 5, v50
    v_add_u32 v51, v51, v52
    v_lshlrev_b32 v52, 3, v49
    v_add_u32 v51, v51, v52
    v_lshlrev_b32 v52, 7, v48
    v_add_u32 v51, v51, v52
    v_lshlrev_b32 v52, 10, v46
    v_add_u32 v3, v51, v52
    v_xor_b32 v4, 64, v3
    v_add_u32 v5, 65536, v3
    v_add_u32 v6, 65536, v4
    v_add_u32 v7, 131072, v3
    v_add_u32 v8, 131072, v4
    v_lshlrev_b32 v24, 1, v47
    v_mov_b32 v51, 0x7ffffff0
    v_cmp_gt_u32 vcc, 32, v0
    s_nop 1
    v_cndmask_b32 v24, v51, v24, vcc
    v_mov_b32 v51, 0x3f80
    v_cndmask_b32 v56, 0, v51, vcc
    v_mov_b32 v57, 0
    v_mov_b32 v58, 0
    v_mov_b32 v59, 0
    v_mov_b32 v17, 0
    v_mov_b32 v18, 0
    v_mov_b32 v19, 0
    v_mov_b32 v21, 0
    v_mov_b32 v22, 0
    v_mov_b32 v23, 0
    v_lshlrev_b32 v25, 11, v47
    v_lshlrev_b32 v52, 4, v46
    v_add_u32 v25, v25, v52
    v_lshrrev_b32 v51, 4, v0
    v_and_b32 v52, 15, v0
    v_xor_b32 v52, v52, v51
    v_lshlrev_b32 v51, 11, v51
    v_xor_b32 v53, 0, v52
    v_lshlrev_b32 v53, 4, v53
    v_add_u32 v53, v53, v51
    v_add_u32 v42, 0, v53
    v_xor_b32 v53, 4, v52
    v_lshlrev_b32 v53, 4, v53
    v_add_u32 v53, v53, v51
    v_add_u32 v43, 7168, v53
    v_xor_b32 v53, 8, v52
    v_lshlrev_b32 v53, 4, v53
    v_add_u32 v53, v53, v51
    v_add_u32 v44, 14336, v53
    v_xor_b32 v53, 12, v52
    v_lshlrev_b32 v53, 4, v53
    v_add_u32 v53, v53, v51
    v_add_u32 v45, 21504, v53
    v_and_b32 v51, 15, v47
    v_xor_b32 v52, v51, v46
    v_lshlrev_b32 v52, 4, v52
    v_lshlrev_b32 v53, 8, v47
    v_add_u32 v53, s42, v53
    v_add_u32 v53, 98304, v53
    v_add_u32 v52, v52, v53
    v_xor_b32 v34, 0, v52
    v_xor_b32 v35, 32, v52
    v_xor_b32 v36, 64, v52
    v_xor_b32 v37, 96, v52
    v_xor_b32 v38, 128, v52
    v_xor_b32 v39, 160, v52
    v_xor_b32 v40, 192, v52
    v_xor_b32 v41, 224, v52
    v_lshlrev_b32 v51, 4, v51
    v_add_u32 v52, v51, v53
    v_lshlrev_b32 v51, 3, v46
    v_add_u32 v52, v52, v51
    v_lshrrev_b32 v51, 4, v0
    v_lshlrev_b32 v51, 11, v51
    v_and_b32 v51, 15, v0
    v_lshlrev_b32 v51, 7, v51
    v_add_u32 v51, v51, v51
    s_lshr_b32 s70, s2, 3
    s_lshl_b32 s70, s70, 2
    s_add_u32 s70, s70, s30
    s_lshl_b32 s70, s70, 14
    s_mov_b32 s78, s70
    s_add_u32 s79, s78, 2097152
    s_add_u32 s80, s78, 4194304
    s_waitcnt lgkmcnt(0)
    s_mov_b32 s4, s44
    s_and_b32 s5, s45, 0xffff
    s_mov_b32 s6, 8388608
    s_mov_b32 s7, 0x00020000
    s_mov_b32 s8, s46
    s_and_b32 s9, s47, 0xffff
    s_mov_b32 s10, 6291456
    s_mov_b32 s11, 0x00020000
    s_mov_b32 s12, s48
    s_and_b32 s13, s49, 0xffff
    s_mov_b32 s14, 6144
    s_mov_b32 s15, 0x00020000
    s_mov_b32 s16, s50
    s_and_b32 s17, s51, 0xffff
    s_mov_b32 s18, 8388608
    s_mov_b32 s19, 0x00020000
    s_mov_b32 s24, s64
    s_and_b32 s25, s65, 0xffff
    s_mov_b32 s26, 256
    s_mov_b32 s27, 0x00020000
    s_mov_b32 s20, s66
    s_and_b32 s21, s67, 0xffff
    s_mov_b32 s22, 268435456
    s_mov_b32 s23, 0x00020000
    v_lshrrev_b32 v51, 2, v0
    v_lshlrev_b32 v51, 11, v51
    v_and_b32 v46, 2, v0
    v_lshlrev_b32 v46, 9, v46
    v_add_u32 v51, v51, v46
    v_and_b32 v46, 1, v0
    v_lshlrev_b32 v46, 6, v46
    v_add_u32 v51, v51, v46
    v_add_u32 v51, 384, v51
    v_mov_b32 v46, 0x7ffffff0
    v_cmp_gt_u32 vcc, 32, v0
    s_nop 1
    v_cndmask_b32 v51, v46, v51, vcc
    buffer_load_dword v62, v51, s[8:11], s78 offen
    s_add_u32 s45, s56, 0
    s_add_u32 s46, s56, 2048
    s_add_u32 s47, s56, 4096
    buffer_load_ushort v16, v24, s[12:15], s45 offen offset:0
    buffer_load_ushort v20, v24, s[12:15], s45 offen offset:64
    s_add_u32 m0, s42, 0
    s_add_u32 s44, s82, 0
    buffer_load_dwordx4 v9, s[8:11], s44 offen lds
    buffer_load_dwordx4 v10, s[8:11], s44 offen offset:1024 lds
    buffer_load_dwordx4 v11, s[8:11], s44 offen offset:2048 lds
    buffer_load_dwordx4 v12, s[8:11], s44 offen offset:3072 lds
    s_add_u32 m0, s42, 4096
    s_add_u32 s44, s82, 65536
    buffer_load_dwordx4 v9, s[8:11], s44 offen lds
    buffer_load_dwordx4 v10, s[8:11], s44 offen offset:1024 lds
    buffer_load_dwordx4 v11, s[8:11], s44 offen offset:2048 lds
    buffer_load_dwordx4 v12, s[8:11], s44 offen offset:3072 lds
    s_add_u32 m0, s42, 98304
    s_add_u32 s51, s86, 0
    buffer_load_dwordx4 v42, s[4:7], s51 offen lds
    buffer_load_dwordx4 v43, s[4:7], s51 offen offset:1024 lds
    buffer_load_dwordx4 v44, s[4:7], s51 offen offset:2048 lds
    buffer_load_dwordx4 v45, s[4:7], s51 offen offset:3072 lds
    s_add_u32 m0, s42, 102400
    s_add_u32 s51, s86, 32768
    buffer_load_dwordx4 v42, s[4:7], s51 offen lds
    buffer_load_dwordx4 v43, s[4:7], s51 offen offset:1024 lds
    buffer_load_dwordx4 v44, s[4:7], s51 offen offset:2048 lds
    buffer_load_dwordx4 v45, s[4:7], s51 offen offset:3072 lds
    v_mov_b32 v27, 0
    buffer_store_dword v27, v26, s[20:23], 0 offen sc1
    v_lshlrev_b32 v48, 6, v0
    v_mov_b32 v46, 0x7ffffff0
    v_cmp_gt_u32 vcc, 32, v0
    s_lshl_b32 s70, s2, 2
    v_cndmask_b32 v48, v46, v48, vcc
    s_add_u32 s70, s70, s30
    s_lshl_b32 s94, s70, 11
    s_add_u32 s95, s94, 2097152
    s_add_u32 s96, s94, 4194304
    buffer_load_dword v60, v48, s[8:11], s94 offen
    s_add_u32 m0, s42, 131072
    s_add_u32 s51, s87, 0
    buffer_load_dwordx4 v42, s[4:7], s51 offen lds
    buffer_load_dwordx4 v43, s[4:7], s51 offen offset:1024 lds
    buffer_load_dwordx4 v44, s[4:7], s51 offen offset:2048 lds
    buffer_load_dwordx4 v45, s[4:7], s51 offen offset:3072 lds
    s_add_u32 m0, s42, 135168
    s_add_u32 s51, s87, 32768
    buffer_load_dwordx4 v42, s[4:7], s51 offen lds
    buffer_load_dwordx4 v43, s[4:7], s51 offen offset:1024 lds
    buffer_load_dwordx4 v44, s[4:7], s51 offen offset:2048 lds
    buffer_load_dwordx4 v45, s[4:7], s51 offen offset:3072 lds
    s_add_u32 m0, s42, 65536
    s_add_u32 s51, s88, 0
    buffer_load_dwordx4 v42, s[4:7], s51 offen lds
    buffer_load_dwordx4 v43, s[4:7], s51 offen offset:1024 lds
    buffer_load_dwordx4 v44, s[4:7], s51 offen offset:2048 lds
    buffer_load_dwordx4 v45, s[4:7], s51 offen offset:3072 lds
    s_add_u32 m0, s42, 69632
    s_add_u32 s51, s88, 32768
    buffer_load_dwordx4 v42, s[4:7], s51 offen lds
    buffer_load_dwordx4 v43, s[4:7], s51 offen offset:1024 lds
    buffer_load_dwordx4 v44, s[4:7], s51 offen offset:2048 lds
    buffer_load_dwordx4 v45, s[4:7], s51 offen offset:3072 lds
    s_add_u32 m0, s42, 32768
    s_add_u32 s44, s82, 128
    buffer_load_dwordx4 v9, s[8:11], s44 offen lds
    buffer_load_dwordx4 v10, s[8:11], s44 offen offset:1024 lds
    buffer_load_dwordx4 v11, s[8:11], s44 offen offset:2048 lds
    buffer_load_dwordx4 v12, s[8:11], s44 offen offset:3072 lds
    s_add_u32 m0, s42, 36864
    s_add_u32 s44, s82, 65664
    buffer_load_dwordx4 v9, s[8:11], s44 offen lds
    buffer_load_dwordx4 v10, s[8:11], s44 offen offset:1024 lds
    buffer_load_dwordx4 v11, s[8:11], s44 offen offset:2048 lds
    buffer_load_dwordx4 v12, s[8:11], s44 offen offset:3072 lds
    s_waitcnt vmcnt(34)
    s_waitcnt vmcnt(26)
    ds_read_b128 v[192:195], v34 offset:0
    ds_read_b128 v[196:199], v35 offset:0
    ds_read_b128 a[0:3], v36 offset:0
    ds_read_b128 a[4:7], v37 offset:0
    ds_read_b128 a[8:11], v38 offset:0
    ds_read_b128 a[12:15], v39 offset:0
    ds_read_b128 a[16:19], v40 offset:0
    ds_read_b128 a[20:23], v41 offset:0
    v_xor_b32 v46, 0, v52
    ds_read_b64 v[130:131], v46
    v_xor_b32 v46, 16, v52
    ds_read_b64 v[134:135], v46
    v_xor_b32 v46, 32, v52
    ds_read_b64 v[138:139], v46
    v_xor_b32 v46, 48, v52
    ds_read_b64 v[142:143], v46
    v_xor_b32 v46, 64, v52
    ds_read_b64 v[146:147], v46
    v_xor_b32 v46, 80, v52
    ds_read_b64 v[150:151], v46
    v_xor_b32 v46, 96, v52
    ds_read_b64 v[154:155], v46
    v_xor_b32 v46, 112, v52
    ds_read_b64 v[158:159], v46
    v_xor_b32 v46, 128, v52
    ds_read_b64 v[162:163], v46
    v_xor_b32 v46, 144, v52
    ds_read_b64 v[166:167], v46
    v_xor_b32 v46, 160, v52
    ds_read_b64 v[170:171], v46
    v_xor_b32 v46, 176, v52
    ds_read_b64 v[174:175], v46
    v_xor_b32 v46, 192, v52
    ds_read_b64 v[178:179], v46
    v_xor_b32 v46, 208, v52
    ds_read_b64 v[182:183], v46
    v_xor_b32 v46, 224, v52
    ds_read_b64 v[186:187], v46
    v_xor_b32 v46, 240, v52
    ds_read_b64 v[190:191], v46
    s_waitcnt lgkmcnt(0)
    s_add_u32 m0, s42, 98304
    s_add_u32 s51, s89, 0
    buffer_load_dwordx4 v42, s[4:7], s51 offen lds
    buffer_load_dwordx4 v43, s[4:7], s51 offen offset:1024 lds
    buffer_load_dwordx4 v44, s[4:7], s51 offen offset:2048 lds
    buffer_load_dwordx4 v45, s[4:7], s51 offen offset:3072 lds
    s_add_u32 m0, s42, 102400
    s_add_u32 s51, s89, 32768
    buffer_load_dwordx4 v42, s[4:7], s51 offen lds
    buffer_load_dwordx4 v43, s[4:7], s51 offen offset:1024 lds
    buffer_load_dwordx4 v44, s[4:7], s51 offen offset:2048 lds
    buffer_load_dwordx4 v45, s[4:7], s51 offen offset:3072 lds
    s_barrier
    ds_read_b64_tr_b16 v[224:225], v3 offset:0
    ds_read_b64_tr_b16 v[226:227], v3 offset:512
    ds_read_b64_tr_b16 v[228:229], v3 offset:2048
    ds_read_b64_tr_b16 v[230:231], v3 offset:2560
    ds_read_b64_tr_b16 v[232:233], v4 offset:0
    ds_read_b64_tr_b16 v[234:235], v4 offset:512
    ds_read_b64_tr_b16 v[236:237], v4 offset:2048
    ds_read_b64_tr_b16 v[238:239], v4 offset:2560
    v_mfma_f32_32x32x16_bf16 v[64:79], v[16:19], v[56:59], 0
    ds_read_b64_tr_b16 v[240:241], v3 offset:4096
    ds_read_b64_tr_b16 v[242:243], v3 offset:4608
    s_waitcnt lgkmcnt(6)
    v_mfma_f32_32x32x16_bf16 v[64:79], v[224:227], v[192:195], v[64:79]
    ds_read_b64_tr_b16 v[244:245], v3 offset:6144
    ds_read_b64_tr_b16 v[246:247], v3 offset:6656
    v_mfma_f32_32x32x16_bf16 v[64:79], v[228:231], v[196:199], v[64:79]
    v_mfma_f32_32x32x16_bf16 v[80:95], v[20:23], v[56:59], 0
    buffer_load_ushort v16, v24, s[12:15], s45 offen offset:128
    ds_read_b64_tr_b16 v[224:225], v4 offset:4096
    ds_read_b64_tr_b16 v[226:227], v4 offset:4608
    s_waitcnt lgkmcnt(6)
    v_mfma_f32_32x32x16_bf16 v[80:95], v[232:235], v[192:195], v[80:95]
    s_waitcnt vmcnt(25)
    ds_read_b64_tr_b16 v[228:229], v4 offset:6144
    ds_read_b64_tr_b16 v[230:231], v4 offset:6656
    v_mfma_f32_32x32x16_bf16 v[80:95], v[236:239], v[196:199], v[80:95]
    buffer_load_ushort v20, v24, s[12:15], s45 offen offset:192
    ds_read_b128 a[24:27], v34 offset:32768
    ds_read_b64_tr_b16 v[232:233], v3 offset:8192
    ds_read_b64_tr_b16 v[234:235], v3 offset:8704
    s_waitcnt lgkmcnt(7)
    v_mfma_f32_32x32x16_bf16 v[64:79], v[240:243], a[0:3], v[64:79]
    ds_read_b128 a[28:31], v35 offset:32768
    ds_read_b64_tr_b16 v[236:237], v3 offset:10240
    ds_read_b64_tr_b16 v[238:239], v3 offset:10752
    v_mfma_f32_32x32x16_bf16 v[64:79], v[244:247], a[4:7], v[64:79]
    ds_read_b128 a[32:35], v36 offset:32768
    ds_read_b128 a[36:39], v37 offset:32768
    ds_read_b64_tr_b16 v[240:241], v4 offset:8192
    ds_read_b64_tr_b16 v[242:243], v4 offset:8704
    s_waitcnt lgkmcnt(10)
    v_mfma_f32_32x32x16_bf16 v[80:95], v[224:227], a[0:3], v[80:95]
    ds_read_b128 a[40:43], v38 offset:32768
    ds_read_b64_tr_b16 v[244:245], v4 offset:10240
    ds_read_b64_tr_b16 v[246:247], v4 offset:10752
    v_mfma_f32_32x32x16_bf16 v[80:95], v[228:231], a[4:7], v[80:95]
    ds_read_b128 a[44:47], v39 offset:32768
    ds_read_b128 a[48:51], v40 offset:32768
    buffer_load_dword v60, v48, s[8:11], s95 offen
    ds_read_b64_tr_b16 v[224:225], v3 offset:12288
    ds_read_b64_tr_b16 v[226:227], v3 offset:12800
    s_waitcnt lgkmcnt(11)
    v_mfma_f32_32x32x16_bf16 v[64:79], v[232:235], a[8:11], v[64:79]
    ds_read_b128 a[52:55], v41 offset:32768
    ds_read_b64_tr_b16 v[228:229], v3 offset:14336
    ds_read_b64_tr_b16 v[230:231], v3 offset:14848
    v_mfma_f32_32x32x16_bf16 v[64:79], v[236:239], a[12:15], v[64:79]
    s_waitcnt vmcnt(19)
    v_add_u32 v46, -32768, v34
    ds_read_b128 v[200:203], v46
    ds_read_b64_tr_b16 v[232:233], v4 offset:12288
    ds_read_b64_tr_b16 v[234:235], v4 offset:12800
    s_waitcnt lgkmcnt(10)
    v_mfma_f32_32x32x16_bf16 v[80:95], v[240:243], a[8:11], v[80:95]
    v_add_u32 v46, -32768, v35
    ds_read_b128 v[204:207], v46
    s_waitcnt lgkmcnt(6)
    s_add_u32 m0, s42, 131072
    s_add_u32 s51, s90, 0
    ds_read_b64_tr_b16 v[236:237], v4 offset:14336
    ds_read_b64_tr_b16 v[238:239], v4 offset:14848
    buffer_load_dwordx4 v42, s[4:7], s51 offen lds
    v_mfma_f32_32x32x16_bf16 v[80:95], v[244:247], a[12:15], v[80:95]
    v_add_u32 v46, -32768, v36
    ds_read_b128 a[56:59], v46
    v_add_u32 v46, -32768, v37
    ds_read_b128 a[60:63], v46
    ds_read_b64_tr_b16 v[240:241], v3 offset:16384
    ds_read_b64_tr_b16 v[242:243], v3 offset:16896
    s_waitcnt lgkmcnt(10)
    v_mfma_f32_32x32x16_bf16 v[64:79], v[224:227], a[16:19], v[64:79]
    v_add_u32 v46, -32768, v38
    ds_read_b128 a[64:67], v46
    ds_read_b64_tr_b16 v[244:245], v3 offset:18432
    ds_read_b64_tr_b16 v[246:247], v3 offset:18944
    buffer_load_dwordx4 v43, s[4:7], s51 offen offset:1024 lds
    v_mfma_f32_32x32x16_bf16 v[64:79], v[228:231], a[20:23], v[64:79]
    v_add_u32 v46, -32768, v39
    ds_read_b128 a[68:71], v46
    v_add_u32 v46, -32768, v40
    ds_read_b128 a[72:75], v46
    ds_read_b64_tr_b16 v[224:225], v4 offset:16384
    ds_read_b64_tr_b16 v[226:227], v4 offset:16896
    s_waitcnt lgkmcnt(11)
    v_mfma_f32_32x32x16_bf16 v[80:95], v[232:235], a[16:19], v[80:95]
    v_add_u32 v46, -32768, v41
    ds_read_b128 a[76:79], v46
    ds_read_b64_tr_b16 v[228:229], v4 offset:18432
    ds_read_b64_tr_b16 v[230:231], v4 offset:18944
    buffer_load_dwordx4 v44, s[4:7], s51 offen offset:2048 lds
    v_mfma_f32_32x32x16_bf16 v[80:95], v[236:239], a[20:23], v[80:95]
    ds_read_b64_tr_b16 v[232:233], v3 offset:20480
    ds_read_b64_tr_b16 v[234:235], v3 offset:20992
    s_waitcnt lgkmcnt(9)
    v_mfma_f32_32x32x16_bf16 v[64:79], v[240:243], a[24:27], v[64:79]
    ds_read_b64_tr_b16 v[236:237], v3 offset:22528
    ds_read_b64_tr_b16 v[238:239], v3 offset:23040
    buffer_load_dwordx4 v45, s[4:7], s51 offen offset:3072 lds
    v_mfma_f32_32x32x16_bf16 v[64:79], v[244:247], a[28:31], v[64:79]
    s_waitcnt vmcnt(15)
    s_barrier
    ds_read_b64_tr_b16 v[240:241], v4 offset:20480
    ds_read_b64_tr_b16 v[242:243], v4 offset:20992
    s_waitcnt lgkmcnt(6)
    v_mfma_f32_32x32x16_bf16 v[80:95], v[224:227], a[24:27], v[80:95]
    s_add_u32 m0, s42, 65536
    s_add_u32 s44, s83, 0
    ds_read_b64_tr_b16 v[244:245], v4 offset:22528
    ds_read_b64_tr_b16 v[246:247], v4 offset:23040
    buffer_load_dwordx4 v9, s[8:11], s44 offen lds
    v_mfma_f32_32x32x16_bf16 v[80:95], v[228:231], a[28:31], v[80:95]
    v_lshlrev_b32 v128, 16, v130
    v_and_b32 v129, s58, v130
    ds_read_b64_tr_b16 v[224:225], v3 offset:24576
    ds_read_b64_tr_b16 v[226:227], v3 offset:25088
    buffer_load_dwordx4 v10, s[8:11], s44 offen offset:1024 lds
    s_waitcnt lgkmcnt(6)
    v_mfma_f32_32x32x16_bf16 v[64:79], v[232:235], a[32:35], v[64:79]
    v_lshlrev_b32 v130, 16, v131
    ds_read_b64_tr_b16 v[228:229], v3 offset:26624
    ds_read_b64_tr_b16 v[230:231], v3 offset:27136
    buffer_load_dwordx4 v11, s[8:11], s44 offen offset:2048 lds
    v_mfma_f32_32x32x16_bf16 v[64:79], v[236:239], a[36:39], v[64:79]
    v_and_b32 v131, s58, v131
    v_lshlrev_b32 v132, 16, v134
    ds_read_b64_tr_b16 v[232:233], v4 offset:24576
    ds_read_b64_tr_b16 v[234:235], v4 offset:25088
    buffer_load_dwordx4 v12, s[8:11], s44 offen offset:3072 lds
    s_waitcnt lgkmcnt(6)
    v_mfma_f32_32x32x16_bf16 v[80:95], v[240:243], a[32:35], v[80:95]
    v_and_b32 v133, s58, v134
    s_add_u32 m0, s42, 69632
    s_add_u32 s44, s83, 65536
    ds_read_b64_tr_b16 v[236:237], v4 offset:26624
    ds_read_b64_tr_b16 v[238:239], v4 offset:27136
    buffer_load_dwordx4 v9, s[8:11], s44 offen lds
    v_mfma_f32_32x32x16_bf16 v[80:95], v[244:247], a[36:39], v[80:95]
    v_lshlrev_b32 v134, 16, v135
    v_and_b32 v135, s58, v135
    ds_read_b64_tr_b16 v[240:241], v3 offset:28672
    ds_read_b64_tr_b16 v[242:243], v3 offset:29184
    buffer_load_dwordx4 v10, s[8:11], s44 offen offset:1024 lds
    s_waitcnt lgkmcnt(6)
    v_mfma_f32_32x32x16_bf16 v[64:79], v[224:227], a[40:43], v[64:79]
    v_lshlrev_b32 v136, 16, v138
    ds_read_b64_tr_b16 v[244:245], v3 offset:30720
    ds_read_b64_tr_b16 v[246:247], v3 offset:31232
    buffer_load_dwordx4 v11, s[8:11], s44 offen offset:2048 lds
    v_mfma_f32_32x32x16_bf16 v[64:79], v[228:231], a[44:47], v[64:79]
    v_and_b32 v137, s58, v138
    v_lshlrev_b32 v138, 16, v139
    ds_read_b64_tr_b16 v[224:225], v4 offset:28672
    ds_read_b64_tr_b16 v[226:227], v4 offset:29184
    buffer_load_dwordx4 v12, s[8:11], s44 offen offset:3072 lds
    s_waitcnt lgkmcnt(6)
    v_mfma_f32_32x32x16_bf16 v[80:95], v[232:235], a[40:43], v[80:95]
    v_and_b32 v139, s58, v139
    s_add_u32 m0, s42, 135168
    s_add_u32 s51, s90, 32768
    ds_read_b64_tr_b16 v[228:229], v4 offset:30720
    ds_read_b64_tr_b16 v[230:231], v4 offset:31232
    buffer_load_dwordx4 v42, s[4:7], s51 offen lds
    v_mfma_f32_32x32x16_bf16 v[80:95], v[236:239], a[44:47], v[80:95]
    v_lshlrev_b32 v140, 16, v142
    v_and_b32 v141, s58, v142
    ds_read_b64_tr_b16 v[232:233], v3 offset:32768
    ds_read_b64_tr_b16 v[234:235], v3 offset:33280
    s_waitcnt lgkmcnt(6)
    v_mfma_f32_32x32x16_bf16 v[64:79], v[240:243], a[48:51], v[64:79]
    v_lshlrev_b32 v142, 16, v143
    ds_read_b64_tr_b16 v[236:237], v3 offset:34816
    ds_read_b64_tr_b16 v[238:239], v3 offset:35328
    buffer_load_dwordx4 v43, s[4:7], s51 offen offset:1024 lds
    v_mfma_f32_32x32x16_bf16 v[64:79], v[244:247], a[52:55], v[64:79]
    v_and_b32 v143, s58, v143
    v_lshlrev_b32 v144, 16, v146
    ds_read_b64_tr_b16 v[240:241], v3 offset:36864
    ds_read_b64_tr_b16 v[242:243], v3 offset:37376
    s_waitcnt lgkmcnt(6)
    v_mfma_f32_32x32x16_bf16 v[80:95], v[224:227], a[48:51], v[80:95]
    v_and_b32 v145, s58, v146
    ds_read_b64_tr_b16 v[244:245], v3 offset:38912
    ds_read_b64_tr_b16 v[246:247], v3 offset:39424
    buffer_load_dwordx4 v44, s[4:7], s51 offen offset:2048 lds
    v_mfma_f32_32x32x16_bf16 v[80:95], v[228:231], a[52:55], v[80:95]
    s_waitcnt vmcnt(17)
    v_mfma_f32_32x32x16_bf16 v[96:111], v[16:19], v[56:59], 0
    v_lshlrev_b32 v146, 16, v147
    v_and_b32 v147, s58, v147
    ds_read_b64_tr_b16 v[224:225], v3 offset:40960
    ds_read_b64_tr_b16 v[226:227], v3 offset:41472
    s_waitcnt lgkmcnt(6)
    v_mfma_f32_32x32x16_bf16 v[96:111], v[232:235], v[192:195], v[96:111]
    v_lshlrev_b32 v148, 16, v150
    ds_read_b64_tr_b16 v[228:229], v3 offset:43008
    ds_read_b64_tr_b16 v[230:231], v3 offset:43520
    buffer_load_dwordx4 v45, s[4:7], s51 offen offset:3072 lds
    v_mfma_f32_32x32x16_bf16 v[96:111], v[236:239], v[196:199], v[96:111]
    v_and_b32 v149, s58, v150
    v_lshlrev_b32 v150, 16, v151
    ds_read_b64_tr_b16 v[232:233], v3 offset:45056
    ds_read_b64_tr_b16 v[234:235], v3 offset:45568
    s_waitcnt lgkmcnt(6)
    v_mfma_f32_32x32x16_bf16 v[96:111], v[240:243], a[0:3], v[96:111]
    v_and_b32 v151, s58, v151
    ds_read_b64_tr_b16 v[236:237], v3 offset:47104
    ds_read_b64_tr_b16 v[238:239], v3 offset:47616
    v_mfma_f32_32x32x16_bf16 v[96:111], v[244:247], a[4:7], v[96:111]
    v_lshlrev_b32 v152, 16, v154
    v_and_b32 v153, s58, v154
    ds_read_b64_tr_b16 v[240:241], v3 offset:49152
    ds_read_b64_tr_b16 v[242:243], v3 offset:49664
    s_waitcnt lgkmcnt(6)
    v_mfma_f32_32x32x16_bf16 v[96:111], v[224:227], a[8:11], v[96:111]
    v_lshlrev_b32 v154, 16, v155
    ds_read_b64_tr_b16 v[244:245], v3 offset:51200
    ds_read_b64_tr_b16 v[246:247], v3 offset:51712
    v_mfma_f32_32x32x16_bf16 v[96:111], v[228:231], a[12:15], v[96:111]
    v_and_b32 v155, s58, v155
    v_lshlrev_b32 v156, 16, v158
    ds_read_b64_tr_b16 v[224:225], v3 offset:53248
    ds_read_b64_tr_b16 v[226:227], v3 offset:53760
    s_waitcnt lgkmcnt(6)
    v_mfma_f32_32x32x16_bf16 v[96:111], v[232:235], a[16:19], v[96:111]
    v_and_b32 v157, s58, v158
    ds_read_b64_tr_b16 v[228:229], v3 offset:55296
    ds_read_b64_tr_b16 v[230:231], v3 offset:55808
    v_mfma_f32_32x32x16_bf16 v[96:111], v[236:239], a[20:23], v[96:111]
    v_lshlrev_b32 v158, 16, v159
    v_and_b32 v159, s58, v159
    ds_read_b64_tr_b16 v[232:233], v3 offset:57344
    ds_read_b64_tr_b16 v[234:235], v3 offset:57856
    s_waitcnt lgkmcnt(6)
    v_mfma_f32_32x32x16_bf16 v[96:111], v[240:243], a[24:27], v[96:111]
    v_lshlrev_b32 v160, 16, v162
    ds_read_b64_tr_b16 v[236:237], v3 offset:59392
    ds_read_b64_tr_b16 v[238:239], v3 offset:59904
    v_mfma_f32_32x32x16_bf16 v[96:111], v[244:247], a[28:31], v[96:111]
    v_and_b32 v161, s58, v162
    v_lshlrev_b32 v162, 16, v163
    ds_read_b64_tr_b16 v[240:241], v3 offset:61440
    ds_read_b64_tr_b16 v[242:243], v3 offset:61952
    s_waitcnt lgkmcnt(6)
    v_mfma_f32_32x32x16_bf16 v[96:111], v[224:227], a[32:35], v[96:111]
    v_and_b32 v163, s58, v163
    ds_read_b64_tr_b16 v[244:245], v3 offset:63488
    ds_read_b64_tr_b16 v[246:247], v3 offset:64000
    v_mfma_f32_32x32x16_bf16 v[96:111], v[228:231], a[36:39], v[96:111]
    v_lshlrev_b32 v164, 16, v166
    v_and_b32 v165, s58, v166
    ds_read_b64_tr_b16 v[224:225], v4 offset:32768
    ds_read_b64_tr_b16 v[226:227], v4 offset:33280
    s_waitcnt lgkmcnt(6)
    v_mfma_f32_32x32x16_bf16 v[96:111], v[232:235], a[40:43], v[96:111]
    v_lshlrev_b32 v166, 16, v167
    ds_read_b64_tr_b16 v[228:229], v4 offset:34816
    ds_read_b64_tr_b16 v[230:231], v4 offset:35328
    v_mfma_f32_32x32x16_bf16 v[96:111], v[236:239], a[44:47], v[96:111]
    v_and_b32 v167, s58, v167
    v_lshlrev_b32 v168, 16, v170
    ds_read_b64_tr_b16 v[232:233], v4 offset:36864
    ds_read_b64_tr_b16 v[234:235], v4 offset:37376
    s_waitcnt lgkmcnt(6)
    v_mfma_f32_32x32x16_bf16 v[96:111], v[240:243], a[48:51], v[96:111]
    v_and_b32 v169, s58, v170
    ds_read_b64_tr_b16 v[236:237], v4 offset:38912
    ds_read_b64_tr_b16 v[238:239], v4 offset:39424
    v_mfma_f32_32x32x16_bf16 v[96:111], v[244:247], a[52:55], v[96:111]
    s_waitcnt vmcnt(17)
    v_mfma_f32_32x32x16_bf16 v[112:127], v[20:23], v[56:59], 0
    v_lshlrev_b32 v170, 16, v171
    v_and_b32 v171, s58, v171
    ds_read_b64_tr_b16 v[240:241], v4 offset:40960
    ds_read_b64_tr_b16 v[242:243], v4 offset:41472
    s_waitcnt lgkmcnt(6)
    v_mfma_f32_32x32x16_bf16 v[112:127], v[224:227], v[192:195], v[112:127]
    v_lshlrev_b32 v172, 16, v174
    ds_read_b64_tr_b16 v[244:245], v4 offset:43008
    ds_read_b64_tr_b16 v[246:247], v4 offset:43520
    v_mfma_f32_32x32x16_bf16 v[112:127], v[228:231], v[196:199], v[112:127]
    v_and_b32 v173, s58, v174
    v_lshlrev_b32 v174, 16, v175
    s_waitcnt vmcnt(4)
    s_barrier
    buffer_atomic_add v55, v54, s[24:27], 0 offen sc1
    ds_read_b64_tr_b16 v[224:225], v4 offset:45056
    ds_read_b64_tr_b16 v[226:227], v4 offset:45568
    s_waitcnt lgkmcnt(6)
    v_mfma_f32_32x32x16_bf16 v[112:127], v[232:235], a[0:3], v[112:127]
    v_and_b32 v175, s58, v175
    s_add_u32 m0, s42, 0
    s_add_u32 s44, s84, 0
    ds_read_b64_tr_b16 v[228:229], v4 offset:47104
    ds_read_b64_tr_b16 v[230:231], v4 offset:47616
    buffer_load_dwordx4 v9, s[8:11], s44 offen lds
    v_mfma_f32_32x32x16_bf16 v[112:127], v[236:239], a[4:7], v[112:127]
    v_lshlrev_b32 v176, 16, v178
    v_and_b32 v177, s58, v178
    ds_read_b64_tr_b16 v[232:233], v4 offset:49152
    ds_read_b64_tr_b16 v[234:235], v4 offset:49664
    buffer_load_dwordx4 v10, s[8:11], s44 offen offset:1024 lds
    s_waitcnt lgkmcnt(6)
    v_mfma_f32_32x32x16_bf16 v[112:127], v[240:243], a[8:11], v[112:127]
    v_lshlrev_b32 v178, 16, v179
    ds_read_b64_tr_b16 v[236:237], v4 offset:51200
    ds_read_b64_tr_b16 v[238:239], v4 offset:51712
    buffer_load_dwordx4 v11, s[8:11], s44 offen offset:2048 lds
    v_mfma_f32_32x32x16_bf16 v[112:127], v[244:247], a[12:15], v[112:127]
    v_and_b32 v179, s58, v179
    v_lshlrev_b32 v180, 16, v182
    ds_read_b64_tr_b16 v[240:241], v4 offset:53248
    ds_read_b64_tr_b16 v[242:243], v4 offset:53760
    buffer_load_dwordx4 v12, s[8:11], s44 offen offset:3072 lds
    s_waitcnt lgkmcnt(6)
    v_mfma_f32_32x32x16_bf16 v[112:127], v[224:227], a[16:19], v[112:127]
    v_and_b32 v181, s58, v182
    s_add_u32 m0, s42, 4096
    s_add_u32 s44, s84, 65536
    ds_read_b64_tr_b16 v[244:245], v4 offset:55296
    ds_read_b64_tr_b16 v[246:247], v4 offset:55808
    buffer_load_dwordx4 v9, s[8:11], s44 offen lds
    v_mfma_f32_32x32x16_bf16 v[112:127], v[228:231], a[20:23], v[112:127]
    v_lshlrev_b32 v182, 16, v183
    v_and_b32 v183, s58, v183
    ds_read_b64_tr_b16 v[224:225], v4 offset:57344
    ds_read_b64_tr_b16 v[226:227], v4 offset:57856
    buffer_load_dwordx4 v10, s[8:11], s44 offen offset:1024 lds
    s_waitcnt lgkmcnt(6)
    v_mfma_f32_32x32x16_bf16 v[112:127], v[232:235], a[24:27], v[112:127]
    v_lshlrev_b32 v184, 16, v186
    ds_read_b64_tr_b16 v[228:229], v4 offset:59392
    ds_read_b64_tr_b16 v[230:231], v4 offset:59904
    buffer_load_dwordx4 v11, s[8:11], s44 offen offset:2048 lds
    v_mfma_f32_32x32x16_bf16 v[112:127], v[236:239], a[28:31], v[112:127]
    v_and_b32 v185, s58, v186
    v_lshlrev_b32 v186, 16, v187
    ds_read_b64_tr_b16 v[232:233], v4 offset:61440
    ds_read_b64_tr_b16 v[234:235], v4 offset:61952
    buffer_load_dwordx4 v12, s[8:11], s44 offen offset:3072 lds
    s_waitcnt lgkmcnt(6)
    v_mfma_f32_32x32x16_bf16 v[112:127], v[240:243], a[32:35], v[112:127]
    v_and_b32 v187, s58, v187
    ds_read_b64_tr_b16 v[236:237], v4 offset:63488
    ds_read_b64_tr_b16 v[238:239], v4 offset:64000
    v_mfma_f32_32x32x16_bf16 v[112:127], v[244:247], a[36:39], v[112:127]
    v_lshlrev_b32 v188, 16, v190
    v_and_b32 v189, s58, v190
    ds_read_b64_tr_b16 v[240:241], v5 offset:0
    ds_read_b64_tr_b16 v[242:243], v5 offset:512
    s_waitcnt lgkmcnt(6)
    v_mfma_f32_32x32x16_bf16 v[112:127], v[224:227], a[40:43], v[112:127]
    v_lshlrev_b32 v190, 16, v191
    ds_read_b64_tr_b16 v[244:245], v5 offset:2048
    ds_read_b64_tr_b16 v[246:247], v5 offset:2560
    v_mfma_f32_32x32x16_bf16 v[112:127], v[228:231], a[44:47], v[112:127]
    v_and_b32 v191, s58, v191
    ds_read_b64_tr_b16 v[224:225], v6 offset:0
    ds_read_b64_tr_b16 v[226:227], v6 offset:512
    s_waitcnt lgkmcnt(6)
    v_mfma_f32_32x32x16_bf16 v[112:127], v[232:235], a[48:51], v[112:127]
    ds_read_b128 a[80:83], v34 offset:0
    ds_read_b64_tr_b16 v[228:229], v6 offset:2048
    ds_read_b64_tr_b16 v[230:231], v6 offset:2560
    v_mfma_f32_32x32x16_bf16 v[112:127], v[236:239], a[52:55], v[112:127]
    ds_read_b128 a[84:87], v35 offset:0
    ds_read_b128 a[88:91], v36 offset:0
    ds_read_b64_tr_b16 v[232:233], v5 offset:4096
    ds_read_b64_tr_b16 v[234:235], v5 offset:4608
    s_waitcnt lgkmcnt(9)
    v_mfma_f32_32x32x16_bf16 v[64:79], v[240:243], v[200:203], v[64:79]
    ds_read_b128 a[92:95], v37 offset:0
    ds_read_b64_tr_b16 v[236:237], v5 offset:6144
    ds_read_b64_tr_b16 v[238:239], v5 offset:6656
    v_mfma_f32_32x32x16_bf16 v[64:79], v[244:247], v[204:207], v[64:79]
    ds_read_b128 a[96:99], v38 offset:0
    ds_read_b128 a[100:103], v39 offset:0
    ds_read_b64_tr_b16 v[240:241], v6 offset:4096
    ds_read_b64_tr_b16 v[242:243], v6 offset:4608
    s_waitcnt lgkmcnt(11)
    v_mfma_f32_32x32x16_bf16 v[80:95], v[224:227], v[200:203], v[80:95]
    ds_read_b128 a[104:107], v40 offset:0
    ds_read_b64_tr_b16 v[244:245], v6 offset:6144
    ds_read_b64_tr_b16 v[246:247], v6 offset:6656
    v_mfma_f32_32x32x16_bf16 v[80:95], v[228:231], v[204:207], v[80:95]
    ds_read_b128 a[108:111], v41 offset:0
    s_waitcnt vmcnt(9)
    ds_read_b64_tr_b16 v[224:225], v5 offset:8192
    ds_read_b64_tr_b16 v[226:227], v5 offset:8704
    s_waitcnt lgkmcnt(10)
    v_mfma_f32_32x32x16_bf16 v[64:79], v[232:235], a[56:59], v[64:79]
    ds_read_b128 v[208:211], v34 offset:32768
    s_waitcnt lgkmcnt(3)
    s_add_u32 m0, s42, 98304
    s_add_u32 s51, s91, 0
    ds_read_b64_tr_b16 v[228:229], v5 offset:10240
    ds_read_b64_tr_b16 v[230:231], v5 offset:10752
    buffer_load_dwordx4 v42, s[4:7], s51 offen lds
    v_mfma_f32_32x32x16_bf16 v[64:79], v[236:239], a[60:63], v[64:79]
    ds_read_b128 v[212:215], v35 offset:32768
    ds_read_b128 a[112:115], v36 offset:32768
    ds_read_b64_tr_b16 v[232:233], v6 offset:8192
    ds_read_b64_tr_b16 v[234:235], v6 offset:8704
    buffer_load_dwordx4 v43, s[4:7], s51 offen offset:1024 lds
    v_mfma_f32_32x32x16_bf16 v[80:95], v[240:243], a[56:59], v[80:95]
    ds_read_b128 a[116:119], v37 offset:32768
    ds_read_b64_tr_b16 v[236:237], v6 offset:10240
    ds_read_b64_tr_b16 v[238:239], v6 offset:10752
    buffer_load_dwordx4 v44, s[4:7], s51 offen offset:2048 lds
    v_mfma_f32_32x32x16_bf16 v[80:95], v[244:247], a[60:63], v[80:95]
    ds_read_b128 a[120:123], v38 offset:32768
    ds_read_b128 a[124:127], v39 offset:32768
    ds_read_b64_tr_b16 v[240:241], v5 offset:12288
    ds_read_b64_tr_b16 v[242:243], v5 offset:12800
    buffer_load_dwordx4 v45, s[4:7], s51 offen offset:3072 lds
    s_waitcnt lgkmcnt(11)
    v_mfma_f32_32x32x16_bf16 v[64:79], v[224:227], a[64:67], v[64:79]
    ds_read_b128 a[128:131], v40 offset:32768
    s_add_u32 m0, s42, 102400
    s_add_u32 s51, s91, 32768
    ds_read_b64_tr_b16 v[244:245], v5 offset:14336
    ds_read_b64_tr_b16 v[246:247], v5 offset:14848
    buffer_load_dwordx4 v42, s[4:7], s51 offen lds
    v_mfma_f32_32x32x16_bf16 v[64:79], v[228:231], a[68:71], v[64:79]
    ds_read_b128 a[132:135], v41 offset:32768
    ds_read_b64_tr_b16 v[224:225], v6 offset:12288
    ds_read_b64_tr_b16 v[226:227], v6 offset:12800
    buffer_load_dwordx4 v43, s[4:7], s51 offen offset:1024 lds
    s_waitcnt lgkmcnt(10)
    v_mfma_f32_32x32x16_bf16 v[80:95], v[232:235], a[64:67], v[80:95]
    ds_read_b64_tr_b16 v[228:229], v6 offset:14336
    ds_read_b64_tr_b16 v[230:231], v6 offset:14848
    buffer_load_dwordx4 v44, s[4:7], s51 offen offset:2048 lds
    v_mfma_f32_32x32x16_bf16 v[80:95], v[236:239], a[68:71], v[80:95]
    ds_read_b64_tr_b16 v[232:233], v5 offset:16384
    ds_read_b64_tr_b16 v[234:235], v5 offset:16896
    buffer_load_dwordx4 v45, s[4:7], s51 offen offset:3072 lds
    s_waitcnt lgkmcnt(7)
    v_mfma_f32_32x32x16_bf16 v[64:79], v[240:243], a[72:75], v[64:79]
    s_waitcnt lgkmcnt(6)
    s_add_u32 m0, s42, 131072
    s_add_u32 s51, s92, 0
    ds_read_b64_tr_b16 v[236:237], v5 offset:18432
    ds_read_b64_tr_b16 v[238:239], v5 offset:18944
    buffer_load_dwordx4 v42, s[4:7], s51 offen lds
    v_mfma_f32_32x32x16_bf16 v[64:79], v[244:247], a[76:79], v[64:79]
    ds_read_b64_tr_b16 v[240:241], v6 offset:16384
    ds_read_b64_tr_b16 v[242:243], v6 offset:16896
    s_waitcnt lgkmcnt(6)
    v_mfma_f32_32x32x16_bf16 v[80:95], v[224:227], a[72:75], v[80:95]
    ds_read_b64_tr_b16 v[244:245], v6 offset:18432
    ds_read_b64_tr_b16 v[246:247], v6 offset:18944
    buffer_load_dwordx4 v43, s[4:7], s51 offen offset:1024 lds
    v_mfma_f32_32x32x16_bf16 v[80:95], v[228:231], a[76:79], v[80:95]
    ds_read_b64_tr_b16 v[224:225], v5 offset:20480
    ds_read_b64_tr_b16 v[226:227], v5 offset:20992
    s_waitcnt lgkmcnt(6)
    v_mfma_f32_32x32x16_bf16 v[64:79], v[232:235], a[80:83], v[64:79]
    ds_read_b64_tr_b16 v[228:229], v5 offset:22528
    ds_read_b64_tr_b16 v[230:231], v5 offset:23040
    buffer_load_dwordx4 v44, s[4:7], s51 offen offset:2048 lds
    v_mfma_f32_32x32x16_bf16 v[64:79], v[236:239], a[84:87], v[64:79]
    s_waitcnt vmcnt(11)
    s_barrier
    ds_read_b64_tr_b16 v[232:233], v6 offset:20480
    ds_read_b64_tr_b16 v[234:235], v6 offset:20992
    s_waitcnt lgkmcnt(6)
    v_mfma_f32_32x32x16_bf16 v[80:95], v[240:243], a[80:83], v[80:95]
    s_add_u32 m0, s42, 32768
    s_add_u32 s44, s85, 0
    ds_read_b64_tr_b16 v[236:237], v6 offset:22528
    ds_read_b64_tr_b16 v[238:239], v6 offset:23040
    buffer_load_dwordx4 v9, s[8:11], s44 offen lds
    v_mfma_f32_32x32x16_bf16 v[80:95], v[244:247], a[84:87], v[80:95]
    ds_read_b64_tr_b16 v[240:241], v5 offset:24576
    ds_read_b64_tr_b16 v[242:243], v5 offset:25088
    buffer_load_dwordx4 v10, s[8:11], s44 offen offset:1024 lds
    s_waitcnt lgkmcnt(6)
    v_mfma_f32_32x32x16_bf16 v[64:79], v[224:227], a[88:91], v[64:79]
    ds_read_b64_tr_b16 v[244:245], v5 offset:26624
    ds_read_b64_tr_b16 v[246:247], v5 offset:27136
    buffer_load_dwordx4 v11, s[8:11], s44 offen offset:2048 lds
    v_mfma_f32_32x32x16_bf16 v[64:79], v[228:231], a[92:95], v[64:79]
    ds_read_b64_tr_b16 v[224:225], v6 offset:24576
    ds_read_b64_tr_b16 v[226:227], v6 offset:25088
    buffer_load_dwordx4 v12, s[8:11], s44 offen offset:3072 lds
    s_waitcnt lgkmcnt(6)
    v_mfma_f32_32x32x16_bf16 v[80:95], v[232:235], a[88:91], v[80:95]
    s_add_u32 m0, s42, 36864
    s_add_u32 s44, s85, 65536
    ds_read_b64_tr_b16 v[228:229], v6 offset:26624
    ds_read_b64_tr_b16 v[230:231], v6 offset:27136
    buffer_load_dwordx4 v9, s[8:11], s44 offen lds
    v_mfma_f32_32x32x16_bf16 v[80:95], v[236:239], a[92:95], v[80:95]
    ds_read_b64_tr_b16 v[232:233], v5 offset:28672
    ds_read_b64_tr_b16 v[234:235], v5 offset:29184
    buffer_load_dwordx4 v10, s[8:11], s44 offen offset:1024 lds
    s_waitcnt lgkmcnt(6)
    v_mfma_f32_32x32x16_bf16 v[64:79], v[240:243], a[96:99], v[64:79]
    ds_read_b64_tr_b16 v[236:237], v5 offset:30720
    ds_read_b64_tr_b16 v[238:239], v5 offset:31232
    buffer_load_dwordx4 v11, s[8:11], s44 offen offset:2048 lds
    v_mfma_f32_32x32x16_bf16 v[64:79], v[244:247], a[100:103], v[64:79]
    s_waitcnt vmcnt(10)
    ds_read_b128 a[136:139], v34 offset:0
    ds_read_b64_tr_b16 v[240:241], v6 offset:28672
    ds_read_b64_tr_b16 v[242:243], v6 offset:29184
    buffer_load_dwordx4 v12, s[8:11], s44 offen offset:3072 lds
    s_waitcnt lgkmcnt(7)
    v_mfma_f32_32x32x16_bf16 v[80:95], v[224:227], a[96:99], v[80:95]
    ds_read_b128 a[140:143], v35 offset:0
    s_add_u32 m0, s42, 131072
    ds_read_b64_tr_b16 v[244:245], v6 offset:30720
    ds_read_b64_tr_b16 v[246:247], v6 offset:31232
    buffer_load_dwordx4 v45, s[4:7], s51 offen offset:3072 lds
    v_mfma_f32_32x32x16_bf16 v[80:95], v[228:231], a[100:103], v[80:95]
    ds_read_b128 a[144:147], v36 offset:0
    ds_read_b128 a[148:151], v37 offset:0
    s_add_u32 m0, s42, 135168
    s_add_u32 s51, s92, 32768
    ds_read_b64_tr_b16 v[224:225], v3 offset:0
    ds_read_b64_tr_b16 v[226:227], v3 offset:512
    buffer_load_dwordx4 v42, s[4:7], s51 offen lds
    s_waitcnt lgkmcnt(10)
    v_mfma_f32_32x32x16_bf16 v[64:79], v[232:235], a[104:107], v[64:79]
    ds_read_b128 a[152:155], v38 offset:0
    ds_read_b64_tr_b16 v[228:229], v3 offset:2048
    ds_read_b64_tr_b16 v[230:231], v3 offset:2560
    buffer_load_dwordx4 v43, s[4:7], s51 offen offset:1024 lds
    v_mfma_f32_32x32x16_bf16 v[64:79], v[236:239], a[108:111], v[64:79]
    ds_read_b128 a[156:159], v39 offset:0
    ds_read_b128 a[160:163], v40 offset:0
    ds_read_b64_tr_b16 v[232:233], v4 offset:0
    ds_read_b64_tr_b16 v[234:235], v4 offset:512
    buffer_load_dwordx4 v44, s[4:7], s51 offen offset:2048 lds
    s_waitcnt lgkmcnt(11)
    v_mfma_f32_32x32x16_bf16 v[80:95], v[240:243], a[104:107], v[80:95]
    ds_read_b128 a[164:167], v41 offset:0
    ds_read_b64_tr_b16 v[236:237], v4 offset:2048
    ds_read_b64_tr_b16 v[238:239], v4 offset:2560
    buffer_load_dwordx4 v45, s[4:7], s51 offen offset:3072 lds
    v_mfma_f32_32x32x16_bf16 v[80:95], v[244:247], a[108:111], v[80:95]
    ds_read_b64_tr_b16 v[240:241], v3 offset:4096
    ds_read_b64_tr_b16 v[242:243], v3 offset:4608
    s_waitcnt lgkmcnt(9)
    v_mfma_f32_32x32x16_bf16 v[64:79], v[224:227], v[208:211], v[64:79]
    s_waitcnt lgkmcnt(4)
    s_add_u32 m0, s42, 98304
    s_add_u32 s51, s93, 0
    ds_read_b64_tr_b16 v[244:245], v3 offset:6144
    ds_read_b64_tr_b16 v[246:247], v3 offset:6656
    buffer_load_dwordx4 v42, s[4:7], s51 offen lds
    v_mfma_f32_32x32x16_bf16 v[64:79], v[228:231], v[212:215], v[64:79]
    ds_read_b64_tr_b16 v[224:225], v4 offset:4096
    ds_read_b64_tr_b16 v[226:227], v4 offset:4608
    s_waitcnt lgkmcnt(6)
    v_mfma_f32_32x32x16_bf16 v[80:95], v[232:235], v[208:211], v[80:95]
    ds_read_b64_tr_b16 v[228:229], v4 offset:6144
    ds_read_b64_tr_b16 v[230:231], v4 offset:6656
    buffer_load_dwordx4 v43, s[4:7], s51 offen offset:1024 lds
    v_mfma_f32_32x32x16_bf16 v[80:95], v[236:239], v[212:215], v[80:95]
    buffer_load_dword v60, v48, s[8:11], s96 offen
    ds_read_b64_tr_b16 v[232:233], v3 offset:8192
    ds_read_b64_tr_b16 v[234:235], v3 offset:8704
    s_waitcnt lgkmcnt(6)
    v_mfma_f32_32x32x16_bf16 v[64:79], v[240:243], a[112:115], v[64:79]
    ds_read_b64_tr_b16 v[236:237], v3 offset:10240
    ds_read_b64_tr_b16 v[238:239], v3 offset:10752
    buffer_load_dwordx4 v44, s[4:7], s51 offen offset:2048 lds
    v_mfma_f32_32x32x16_bf16 v[64:79], v[244:247], a[116:119], v[64:79]
    ds_read_b64_tr_b16 v[240:241], v4 offset:8192
    ds_read_b64_tr_b16 v[242:243], v4 offset:8704
    s_waitcnt lgkmcnt(6)
    v_mfma_f32_32x32x16_bf16 v[80:95], v[224:227], a[112:115], v[80:95]
    ds_read_b64_tr_b16 v[244:245], v4 offset:10240
    ds_read_b64_tr_b16 v[246:247], v4 offset:10752
    buffer_load_dwordx4 v45, s[4:7], s51 offen offset:3072 lds
    v_mfma_f32_32x32x16_bf16 v[80:95], v[228:231], a[116:119], v[80:95]
    ds_read_b64_tr_b16 v[224:225], v3 offset:12288
    ds_read_b64_tr_b16 v[226:227], v3 offset:12800
    s_waitcnt lgkmcnt(6)
    v_mfma_f32_32x32x16_bf16 v[64:79], v[232:235], a[120:123], v[64:79]
    s_add_u32 m0, s42, 102400
    s_add_u32 s51, s93, 32768
    ds_read_b64_tr_b16 v[228:229], v3 offset:14336
    ds_read_b64_tr_b16 v[230:231], v3 offset:14848
    buffer_load_dwordx4 v42, s[4:7], s51 offen lds
    v_mfma_f32_32x32x16_bf16 v[64:79], v[236:239], a[124:127], v[64:79]
    ds_read_b64_tr_b16 v[232:233], v4 offset:12288
    ds_read_b64_tr_b16 v[234:235], v4 offset:12800
    s_waitcnt lgkmcnt(6)
    v_mfma_f32_32x32x16_bf16 v[80:95], v[240:243], a[120:123], v[80:95]
    ds_read_b64_tr_b16 v[236:237], v4 offset:14336
    ds_read_b64_tr_b16 v[238:239], v4 offset:14848
    buffer_load_dwordx4 v43, s[4:7], s51 offen offset:1024 lds
    v_mfma_f32_32x32x16_bf16 v[80:95], v[244:247], a[124:127], v[80:95]
    ds_read_b64_tr_b16 v[240:241], v3 offset:16384
    ds_read_b64_tr_b16 v[242:243], v3 offset:16896
    s_waitcnt lgkmcnt(6)
    v_mfma_f32_32x32x16_bf16 v[64:79], v[224:227], a[128:131], v[64:79]
    ds_read_b64_tr_b16 v[244:245], v3 offset:18432
    ds_read_b64_tr_b16 v[246:247], v3 offset:18944
    buffer_load_dwordx4 v44, s[4:7], s51 offen offset:2048 lds
    v_mfma_f32_32x32x16_bf16 v[64:79], v[228:231], a[132:135], v[64:79]
    ds_read_b64_tr_b16 v[224:225], v4 offset:16384
    ds_read_b64_tr_b16 v[226:227], v4 offset:16896
    buffer_load_dwordx4 v45, s[4:7], s51 offen offset:3072 lds
    s_waitcnt lgkmcnt(6)
    v_mfma_f32_32x32x16_bf16 v[80:95], v[232:235], a[128:131], v[80:95]
    ds_read_b64_tr_b16 v[228:229], v4 offset:18432
    ds_read_b64_tr_b16 v[230:231], v4 offset:18944
    v_mfma_f32_32x32x16_bf16 v[80:95], v[236:239], a[132:135], v[80:95]
    s_waitcnt vmcnt(9)
    ds_read_b128 v[216:219], v34 offset:32768
    s_lshl_b32 s49, s28, 2
    v_mov_b32 v50, s49
    buffer_load_dword v49, v50, s[24:27], 0 offen sc1
    ds_read_b64_tr_b16 v[232:233], v3 offset:20480
    ds_read_b64_tr_b16 v[234:235], v3 offset:20992
    s_waitcnt lgkmcnt(7)
    v_mfma_f32_32x32x16_bf16 v[64:79], v[240:243], a[136:139], v[64:79]
    ds_read_b128 v[220:223], v35 offset:32768
    ds_read_b64_tr_b16 v[236:237], v3 offset:22528
    ds_read_b64_tr_b16 v[238:239], v3 offset:23040
    v_mfma_f32_32x32x16_bf16 v[64:79], v[244:247], a[140:143], v[64:79]
    s_barrier
    ds_read_b64_tr_b16 v[240:241], v4 offset:20480
    ds_read_b64_tr_b16 v[242:243], v4 offset:20992
    s_waitcnt lgkmcnt(8)
    v_mfma_f32_32x32x16_bf16 v[80:95], v[224:227], a[136:139], v[80:95]
    ds_read_b128 a[168:171], v36 offset:32768
    s_add_u32 m0, s42, 65536
    s_add_u32 s44, s83, 128
    ds_read_b64_tr_b16 v[244:245], v4 offset:22528
    ds_read_b64_tr_b16 v[246:247], v4 offset:23040
    buffer_load_dwordx4 v9, s[8:11], s44 offen lds
    v_mfma_f32_32x32x16_bf16 v[80:95], v[228:231], a[140:143], v[80:95]
    ds_read_b128 a[172:175], v37 offset:32768
    ds_read_b128 a[176:179], v38 offset:32768
    ds_read_b64_tr_b16 v[224:225], v3 offset:24576
    ds_read_b64_tr_b16 v[226:227], v3 offset:25088
    buffer_load_dwordx4 v10, s[8:11], s44 offen offset:1024 lds
    s_waitcnt lgkmcnt(9)
    v_mfma_f32_32x32x16_bf16 v[64:79], v[232:235], a[144:147], v[64:79]
    ds_read_b128 a[180:183], v39 offset:32768
    ds_read_b64_tr_b16 v[228:229], v3 offset:26624
    ds_read_b64_tr_b16 v[230:231], v3 offset:27136
    buffer_load_dwordx4 v11, s[8:11], s44 offen offset:2048 lds
    v_mfma_f32_32x32x16_bf16 v[64:79], v[236:239], a[148:151], v[64:79]
    ds_read_b128 a[184:187], v40 offset:32768
    ds_read_b128 a[188:191], v41 offset:32768
    ds_read_b64_tr_b16 v[232:233], v4 offset:24576
    ds_read_b64_tr_b16 v[234:235], v4 offset:25088
    buffer_load_dwordx4 v12, s[8:11], s44 offen offset:3072 lds
    s_waitcnt lgkmcnt(11)
    v_mfma_f32_32x32x16_bf16 v[80:95], v[240:243], a[144:147], v[80:95]
    s_add_u32 m0, s42, 69632
    s_add_u32 s44, s83, 65664
    ds_read_b64_tr_b16 v[236:237], v4 offset:26624
    ds_read_b64_tr_b16 v[238:239], v4 offset:27136
    buffer_load_dwordx4 v9, s[8:11], s44 offen lds
    v_mfma_f32_32x32x16_bf16 v[80:95], v[244:247], a[148:151], v[80:95]
    ds_read_b64_tr_b16 v[240:241], v3 offset:28672
    ds_read_b64_tr_b16 v[242:243], v3 offset:29184
    buffer_load_dwordx4 v10, s[8:11], s44 offen offset:1024 lds
    s_waitcnt lgkmcnt(8)
    v_mfma_f32_32x32x16_bf16 v[64:79], v[224:227], a[152:155], v[64:79]
    ds_read_b64_tr_b16 v[244:245], v3 offset:30720
    ds_read_b64_tr_b16 v[246:247], v3 offset:31232
    buffer_load_dwordx4 v11, s[8:11], s44 offen offset:2048 lds
    v_mfma_f32_32x32x16_bf16 v[64:79], v[228:231], a[156:159], v[64:79]
    ds_read_b64_tr_b16 v[224:225], v4 offset:28672
    ds_read_b64_tr_b16 v[226:227], v4 offset:29184
    buffer_load_dwordx4 v12, s[8:11], s44 offen offset:3072 lds
    s_waitcnt lgkmcnt(6)
    v_mfma_f32_32x32x16_bf16 v[80:95], v[232:235], a[152:155], v[80:95]
    ds_read_b64_tr_b16 v[228:229], v4 offset:30720
    ds_read_b64_tr_b16 v[230:231], v4 offset:31232
    v_mfma_f32_32x32x16_bf16 v[80:95], v[236:239], a[156:159], v[80:95]
    ds_read_b64_tr_b16 v[232:233], v3 offset:32768
    ds_read_b64_tr_b16 v[234:235], v3 offset:33280
    s_waitcnt lgkmcnt(6)
    v_mfma_f32_32x32x16_bf16 v[64:79], v[240:243], a[160:163], v[64:79]
    ds_read_b64_tr_b16 v[236:237], v3 offset:34816
    ds_read_b64_tr_b16 v[238:239], v3 offset:35328
    v_mfma_f32_32x32x16_bf16 v[64:79], v[244:247], a[164:167], v[64:79]
    ds_read_b64_tr_b16 v[240:241], v4 offset:32768
    ds_read_b64_tr_b16 v[242:243], v4 offset:33280
    s_waitcnt lgkmcnt(6)
    v_mfma_f32_32x32x16_bf16 v[80:95], v[224:227], a[160:163], v[80:95]
    ds_read_b64_tr_b16 v[244:245], v4 offset:34816
    ds_read_b64_tr_b16 v[246:247], v4 offset:35328
    v_mfma_f32_32x32x16_bf16 v[80:95], v[228:231], a[164:167], v[80:95]
    ds_read_b64_tr_b16 v[224:225], v3 offset:36864
    ds_read_b64_tr_b16 v[226:227], v3 offset:37376
    s_waitcnt lgkmcnt(6)
    v_mfma_f32_32x32x16_bf16 v[64:79], v[232:235], v[216:219], v[64:79]
    ds_read_b64_tr_b16 v[228:229], v3 offset:38912
    ds_read_b64_tr_b16 v[230:231], v3 offset:39424
    v_mfma_f32_32x32x16_bf16 v[64:79], v[236:239], v[220:223], v[64:79]
    ds_read_b64_tr_b16 v[232:233], v4 offset:36864
    ds_read_b64_tr_b16 v[234:235], v4 offset:37376
    s_waitcnt lgkmcnt(6)
    v_mfma_f32_32x32x16_bf16 v[80:95], v[240:243], v[216:219], v[80:95]
    ds_read_b64_tr_b16 v[236:237], v4 offset:38912
    ds_read_b64_tr_b16 v[238:239], v4 offset:39424
    v_mfma_f32_32x32x16_bf16 v[80:95], v[244:247], v[220:223], v[80:95]
    s_waitcnt vmcnt(9)
    ds_read_b128 a[192:195], v34 offset:0
    ds_read_b64_tr_b16 v[240:241], v3 offset:40960
    ds_read_b64_tr_b16 v[242:243], v3 offset:41472
    s_waitcnt lgkmcnt(7)
    v_mfma_f32_32x32x16_bf16 v[64:79], v[224:227], a[168:171], v[64:79]
    ds_read_b128 a[196:199], v35 offset:0
    ds_read_b64_tr_b16 v[244:245], v3 offset:43008
    ds_read_b64_tr_b16 v[246:247], v3 offset:43520
    v_mfma_f32_32x32x16_bf16 v[64:79], v[228:231], a[172:175], v[64:79]
    ds_read_b128 a[200:203], v36 offset:0
    ds_read_b128 a[204:207], v37 offset:0
    ds_read_b64_tr_b16 v[224:225], v4 offset:40960
    ds_read_b64_tr_b16 v[226:227], v4 offset:41472
    s_waitcnt lgkmcnt(10)
    v_mfma_f32_32x32x16_bf16 v[80:95], v[232:235], a[168:171], v[80:95]
    ds_read_b128 a[208:211], v38 offset:0
    ds_read_b64_tr_b16 v[228:229], v4 offset:43008
    ds_read_b64_tr_b16 v[230:231], v4 offset:43520
    v_mfma_f32_32x32x16_bf16 v[80:95], v[236:239], a[172:175], v[80:95]
    ds_read_b128 a[212:215], v39 offset:0
    ds_read_b128 a[216:219], v40 offset:0
    ds_read_b64_tr_b16 v[232:233], v3 offset:45056
    ds_read_b64_tr_b16 v[234:235], v3 offset:45568
    s_waitcnt lgkmcnt(11)
    v_mfma_f32_32x32x16_bf16 v[64:79], v[240:243], a[176:179], v[64:79]
    ds_read_b128 a[220:223], v41 offset:0
    ds_read_b64_tr_b16 v[236:237], v3 offset:47104
    ds_read_b64_tr_b16 v[238:239], v3 offset:47616
    v_mfma_f32_32x32x16_bf16 v[64:79], v[244:247], a[180:183], v[64:79]
    ds_read_b64_tr_b16 v[240:241], v4 offset:45056
    ds_read_b64_tr_b16 v[242:243], v4 offset:45568
    s_waitcnt lgkmcnt(9)
    v_mfma_f32_32x32x16_bf16 v[80:95], v[224:227], a[176:179], v[80:95]
    ds_read_b64_tr_b16 v[244:245], v4 offset:47104
    ds_read_b64_tr_b16 v[246:247], v4 offset:47616
    v_mfma_f32_32x32x16_bf16 v[80:95], v[228:231], a[180:183], v[80:95]
    buffer_load_dword v62, v51, s[8:11], s79 offen
    ds_read_b64_tr_b16 v[224:225], v3 offset:49152
    ds_read_b64_tr_b16 v[226:227], v3 offset:49664
    s_waitcnt lgkmcnt(6)
    v_mfma_f32_32x32x16_bf16 v[64:79], v[232:235], a[184:187], v[64:79]
    ds_read_b64_tr_b16 v[228:229], v3 offset:51200
    ds_read_b64_tr_b16 v[230:231], v3 offset:51712
    v_mfma_f32_32x32x16_bf16 v[64:79], v[236:239], a[188:191], v[64:79]
    ds_read_b64_tr_b16 v[232:233], v4 offset:49152
    ds_read_b64_tr_b16 v[234:235], v4 offset:49664
    s_waitcnt lgkmcnt(6)
    v_mfma_f32_32x32x16_bf16 v[80:95], v[240:243], a[184:187], v[80:95]
    ds_read_b64_tr_b16 v[236:237], v4 offset:51200
    ds_read_b64_tr_b16 v[238:239], v4 offset:51712
    v_mfma_f32_32x32x16_bf16 v[80:95], v[244:247], a[188:191], v[80:95]
    ds_read_b64_tr_b16 v[240:241], v3 offset:53248
    ds_read_b64_tr_b16 v[242:243], v3 offset:53760
    s_waitcnt lgkmcnt(6)
    v_mfma_f32_32x32x16_bf16 v[64:79], v[224:227], a[192:195], v[64:79]
    ds_read_b64_tr_b16 v[244:245], v3 offset:55296
    ds_read_b64_tr_b16 v[246:247], v3 offset:55808
    v_mfma_f32_32x32x16_bf16 v[64:79], v[228:231], a[196:199], v[64:79]
    s_waitcnt vmcnt(1)
    s_barrier
    ds_read_b64_tr_b16 v[224:225], v4 offset:53248
    ds_read_b64_tr_b16 v[226:227], v4 offset:53760
    s_waitcnt lgkmcnt(6)
    v_mfma_f32_32x32x16_bf16 v[80:95], v[232:235], a[192:195], v[80:95]
    s_add_u32 m0, s42, 98304
    s_add_u32 s44, s84, 128
    ds_read_b64_tr_b16 v[228:229], v4 offset:55296
    ds_read_b64_tr_b16 v[230:231], v4 offset:55808
    buffer_load_dwordx4 v9, s[8:11], s44 offen lds
    v_mfma_f32_32x32x16_bf16 v[80:95], v[236:239], a[196:199], v[80:95]
    ds_read_b64_tr_b16 v[232:233], v3 offset:57344
    ds_read_b64_tr_b16 v[234:235], v3 offset:57856
    buffer_load_dwordx4 v10, s[8:11], s44 offen offset:1024 lds
    s_waitcnt lgkmcnt(6)
    v_mfma_f32_32x32x16_bf16 v[64:79], v[240:243], a[200:203], v[64:79]
    ds_read_b64_tr_b16 v[236:237], v3 offset:59392
    ds_read_b64_tr_b16 v[238:239], v3 offset:59904
    buffer_load_dwordx4 v11, s[8:11], s44 offen offset:2048 lds
    v_mfma_f32_32x32x16_bf16 v[64:79], v[244:247], a[204:207], v[64:79]
    ds_read_b64_tr_b16 v[240:241], v4 offset:57344
    ds_read_b64_tr_b16 v[242:243], v4 offset:57856
    buffer_load_dwordx4 v12, s[8:11], s44 offen offset:3072 lds
    s_waitcnt lgkmcnt(6)
    v_mfma_f32_32x32x16_bf16 v[80:95], v[224:227], a[200:203], v[80:95]
    s_add_u32 m0, s42, 102400
    s_add_u32 s44, s84, 65664
    ds_read_b64_tr_b16 v[244:245], v4 offset:59392
    ds_read_b64_tr_b16 v[246:247], v4 offset:59904
    buffer_load_dwordx4 v9, s[8:11], s44 offen lds
    v_mfma_f32_32x32x16_bf16 v[80:95], v[228:231], a[204:207], v[80:95]
    ds_read_b64_tr_b16 v[224:225], v3 offset:61440
    ds_read_b64_tr_b16 v[226:227], v3 offset:61952
    buffer_load_dwordx4 v10, s[8:11], s44 offen offset:1024 lds
    s_waitcnt lgkmcnt(6)
    v_mfma_f32_32x32x16_bf16 v[64:79], v[232:235], a[208:211], v[64:79]
    ds_read_b64_tr_b16 v[228:229], v3 offset:63488
    ds_read_b64_tr_b16 v[230:231], v3 offset:64000
    buffer_load_dwordx4 v11, s[8:11], s44 offen offset:2048 lds
    v_mfma_f32_32x32x16_bf16 v[64:79], v[236:239], a[212:215], v[64:79]
    ds_read_b64_tr_b16 v[232:233], v4 offset:61440
    ds_read_b64_tr_b16 v[234:235], v4 offset:61952
    buffer_load_dwordx4 v12, s[8:11], s44 offen offset:3072 lds
    s_waitcnt lgkmcnt(6)
    v_mfma_f32_32x32x16_bf16 v[80:95], v[240:243], a[208:211], v[80:95]
    s_add_u32 m0, s42, 131072
    s_add_u32 s44, s85, 128
    ds_read_b64_tr_b16 v[236:237], v4 offset:63488
    ds_read_b64_tr_b16 v[238:239], v4 offset:64000
    buffer_load_dwordx4 v9, s[8:11], s44 offen lds
    v_mfma_f32_32x32x16_bf16 v[80:95], v[244:247], a[212:215], v[80:95]
    ds_read_b64_tr_b16 v[240:241], v5 offset:0
    ds_read_b64_tr_b16 v[242:243], v5 offset:512
    s_waitcnt lgkmcnt(6)
    v_mfma_f32_32x32x16_bf16 v[64:79], v[224:227], a[216:219], v[64:79]
    ds_read_b64_tr_b16 v[244:245], v5 offset:2048
    ds_read_b64_tr_b16 v[246:247], v5 offset:2560
    buffer_load_dwordx4 v10, s[8:11], s44 offen offset:1024 lds
    v_mfma_f32_32x32x16_bf16 v[64:79], v[228:231], a[220:223], v[64:79]
L_rdy:
    v_readfirstlane_b32 s70, v49
    s_nop 3
    s_lshr_b32 s71, s70, 4
    s_and_b32 s71, s71, 0x0f0f0f0f
    s_and_b32 s72, s70, 0x0f0f0f0f
    s_add_u32 s71, s71, s72
    s_mul_i32 s71, s71, 0x01010101
    s_lshr_b32 s71, s71, 24
    s_cmp_lg_u32 s71, 8
    s_cbranch_scc1 L_rdy_slow
L_rdy_out:
    s_cmp_eq_u32 s70, s75
    s_cselect_b32 s76, 1, 0
    ds_read_b64_tr_b16 v[224:225], v5 offset:4096
    ds_read_b64_tr_b16 v[226:227], v5 offset:4608
    buffer_load_dwordx4 v11, s[8:11], s44 offen offset:2048 lds
    s_waitcnt lgkmcnt(6)
    v_mfma_f32_32x32x16_bf16 v[80:95], v[232:235], a[216:219], v[80:95]
    ds_read_b64_tr_b16 v[228:229], v5 offset:6144
    ds_read_b64_tr_b16 v[230:231], v5 offset:6656
    buffer_load_dwordx4 v12, s[8:11], s44 offen offset:3072 lds
    v_mfma_f32_32x32x16_bf16 v[80:95], v[236:239], a[220:223], v[80:95]
    s_add_u32 m0, s42, 135168
    s_add_u32 s44, s85, 65664
    ds_read_b64_tr_b16 v[232:233], v5 offset:8192
    ds_read_b64_tr_b16 v[234:235], v5 offset:8704
    buffer_load_dwordx4 v9, s[8:11], s44 offen lds
    s_waitcnt lgkmcnt(6)
    v_mfma_f32_32x32x16_bf16 v[96:111], v[240:243], v[200:203], v[96:111]
    ds_read_b64_tr_b16 v[236:237], v5 offset:10240
    ds_read_b64_tr_b16 v[238:239], v5 offset:10752
    buffer_load_dwordx4 v10, s[8:11], s44 offen offset:1024 lds
    v_mfma_f32_32x32x16_bf16 v[96:111], v[244:247], v[204:207], v[96:111]
    v_fma_f32 v26, v128, v64, v128
    v_fma_f32 v27, v129, v65, v129
    v_cvt_pk_bf16_f32 v192, v26, v27
    ds_read_b64_tr_b16 v[240:241], v5 offset:12288
    ds_read_b64_tr_b16 v[242:243], v5 offset:12800
    buffer_load_dwordx4 v11, s[8:11], s44 offen offset:2048 lds
    s_waitcnt lgkmcnt(6)
    v_mfma_f32_32x32x16_bf16 v[96:111], v[224:227], a[56:59], v[96:111]
    v_fma_f32 v28, v130, v66, v130
    v_fma_f32 v29, v131, v67, v131
    ds_read_b64_tr_b16 v[244:245], v5 offset:14336
    ds_read_b64_tr_b16 v[246:247], v5 offset:14848
    buffer_load_dwordx4 v12, s[8:11], s44 offen offset:3072 lds
    v_mfma_f32_32x32x16_bf16 v[96:111], v[228:231], a[60:63], v[96:111]
    v_cvt_pk_bf16_f32 v193, v28, v29
    v_fma_f32 v30, v132, v68, v132
    v_fma_f32 v31, v133, v69, v133
    ds_read_b64_tr_b16 v[224:225], v5 offset:16384
    ds_read_b64_tr_b16 v[226:227], v5 offset:16896
    s_waitcnt lgkmcnt(6)
    v_mfma_f32_32x32x16_bf16 v[96:111], v[232:235], a[64:67], v[96:111]
    v_cvt_pk_bf16_f32 v194, v30, v31
    v_fma_f32 v32, v134, v70, v134
    s_add_u32 m0, s42, 0
    s_add_u32 s44, s32, 2097152
    ds_read_b64_tr_b16 v[228:229], v5 offset:18432
    ds_read_b64_tr_b16 v[230:231], v5 offset:18944
    buffer_load_dwordx4 v9, s[8:11], s44 offen lds
    v_mfma_f32_32x32x16_bf16 v[96:111], v[236:239], a[68:71], v[96:111]
    v_fma_f32 v33, v135, v71, v135
    v_cvt_pk_bf16_f32 v195, v32, v33
    v_fma_f32 v26, v136, v72, v136
    ds_read_b64_tr_b16 v[232:233], v5 offset:20480
    ds_read_b64_tr_b16 v[234:235], v5 offset:20992
    s_waitcnt lgkmcnt(6)
    v_mfma_f32_32x32x16_bf16 v[96:111], v[240:243], a[72:75], v[96:111]
    v_fma_f32 v27, v137, v73, v137
    v_cvt_pk_bf16_f32 v196, v26, v27
    ds_read_b64_tr_b16 v[236:237], v5 offset:22528
    ds_read_b64_tr_b16 v[238:239], v5 offset:23040
    buffer_load_dwordx4 v10, s[8:11], s44 offen offset:1024 lds
    v_mfma_f32_32x32x16_bf16 v[96:111], v[244:247], a[76:79], v[96:111]
    v_fma_f32 v28, v138, v74, v138
    v_fma_f32 v29, v139, v75, v139
    v_cvt_pk_bf16_f32 v197, v28, v29
    ds_read_b64_tr_b16 v[240:241], v5 offset:24576
    ds_read_b64_tr_b16 v[242:243], v5 offset:25088
    s_waitcnt lgkmcnt(6)
    v_mfma_f32_32x32x16_bf16 v[96:111], v[224:227], a[80:83], v[96:111]
    v_fma_f32 v30, v140, v76, v140
    v_fma_f32 v31, v141, v77, v141
    ds_read_b64_tr_b16 v[244:245], v5 offset:26624
    ds_read_b64_tr_b16 v[246:247], v5 offset:27136
    buffer_load_dwordx4 v11, s[8:11], s44 offen offset:2048 lds
    v_mfma_f32_32x32x16_bf16 v[96:111], v[228:231], a[84:87], v[96:111]
    v_cvt_pk_bf16_f32 v198, v30, v31
    v_fma_f32 v32, v142, v78, v142
    v_fma_f32 v33, v143, v79, v143
    ds_read_b64_tr_b16 v[224:225], v5 offset:28672
    ds_read_b64_tr_b16 v[226:227], v5 offset:29184
    s_waitcnt lgkmcnt(6)
    v_mfma_f32_32x32x16_bf16 v[96:111], v[232:235], a[88:91], v[96:111]
    v_cvt_pk_bf16_f32 v199, v32, v33
    ds_read_b64_tr_b16 v[228:229], v5 offset:30720
    ds_read_b64_tr_b16 v[230:231], v5 offset:31232
    buffer_load_dwordx4 v12, s[8:11], s44 offen offset:3072 lds
    v_mfma_f32_32x32x16_bf16 v[96:111], v[236:239], a[92:95], v[96:111]
    s_add_u32 s48, s34, 16777216
    s_cmp_lg_u32 s76, 0
    s_cbranch_scc0 L_ss0_0
    buffer_store_dwordx4 v[192:195], v1, s[20:23], s48 offen offset:0
    buffer_store_dwordx4 v[196:199], v1, s[20:23], s48 offen offset:1024
L_sj0_0:
    ds_read_b64_tr_b16 v[232:233], v6 offset:0
    ds_read_b64_tr_b16 v[234:235], v6 offset:512
    s_waitcnt lgkmcnt(6)
    v_mfma_f32_32x32x16_bf16 v[96:111], v[240:243], a[96:99], v[96:111]
    v_fma_f32 v26, v144, v80, v144
    v_fma_f32 v27, v145, v81, v145
    s_add_u32 m0, s42, 4096
    s_add_u32 s44, s33, 2097152
    ds_read_b64_tr_b16 v[236:237], v6 offset:2048
    ds_read_b64_tr_b16 v[238:239], v6 offset:2560
    buffer_load_dwordx4 v9, s[8:11], s44 offen lds
    v_mfma_f32_32x32x16_bf16 v[96:111], v[244:247], a[100:103], v[96:111]
    v_cvt_pk_bf16_f32 v34, v26, v27
    v_fma_f32 v28, v146, v82, v146
    v_fma_f32 v29, v147, v83, v147
    ds_read_b64_tr_b16 v[240:241], v6 offset:4096
    ds_read_b64_tr_b16 v[242:243], v6 offset:4608
    s_waitcnt lgkmcnt(6)
    v_mfma_f32_32x32x16_bf16 v[96:111], v[224:227], a[104:107], v[96:111]
    v_cvt_pk_bf16_f32 v35, v28, v29
    v_fma_f32 v30, v148, v84, v148
    ds_read_b64_tr_b16 v[244:245], v6 offset:6144
    ds_read_b64_tr_b16 v[246:247], v6 offset:6656
    buffer_load_dwordx4 v10, s[8:11], s44 offen offset:1024 lds
    v_mfma_f32_32x32x16_bf16 v[96:111], v[228:231], a[108:111], v[96:111]
    v_fma_f32 v31, v149, v85, v149
    v_cvt_pk_bf16_f32 v36, v30, v31
    v_fma_f32 v32, v150, v86, v150
    ds_read_b64_tr_b16 v[224:225], v6 offset:8192
    ds_read_b64_tr_b16 v[226:227], v6 offset:8704
    s_waitcnt lgkmcnt(6)
    v_mfma_f32_32x32x16_bf16 v[112:127], v[232:235], v[200:203], v[112:127]
    v_fma_f32 v33, v151, v87, v151
    v_cvt_pk_bf16_f32 v37, v32, v33
    ds_read_b64_tr_b16 v[228:229], v6 offset:10240
    ds_read_b64_tr_b16 v[230:231], v6 offset:10752
    buffer_load_dwordx4 v11, s[8:11], s44 offen offset:2048 lds
    v_mfma_f32_32x32x16_bf16 v[112:127], v[236:239], v[204:207], v[112:127]
    s_waitcnt vmcnt(17)
    s_barrier
    v_fma_f32 v26, v152, v88, v152
    ds_read_b64_tr_b16 v[232:233], v6 offset:12288
    ds_read_b64_tr_b16 v[234:235], v6 offset:12800
    s_waitcnt lgkmcnt(6)
    v_mfma_f32_32x32x16_bf16 v[112:127], v[240:243], a[56:59], v[112:127]
    v_fma_f32 v27, v153, v89, v153
    v_cvt_pk_bf16_f32 v38, v26, v27
    ds_read_b64_tr_b16 v[236:237], v6 offset:14336
    ds_read_b64_tr_b16 v[238:239], v6 offset:14848
    buffer_load_dwordx4 v12, s[8:11], s44 offen offset:3072 lds
    v_mfma_f32_32x32x16_bf16 v[112:127], v[244:247], a[60:63], v[112:127]
    v_fma_f32 v28, v154, v90, v154
    v_fma_f32 v29, v155, v91, v155
    v_cvt_pk_bf16_f32 v39, v28, v29
    ds_read_b64_tr_b16 v[240:241], v6 offset:16384
    ds_read_b64_tr_b16 v[242:243], v6 offset:16896
    s_waitcnt lgkmcnt(6)
    v_mfma_f32_32x32x16_bf16 v[112:127], v[224:227], a[64:67], v[112:127]
    v_fma_f32 v30, v156, v92, v156
    v_fma_f32 v31, v157, v93, v157
    s_add_u32 m0, s42, 32768
    s_add_u32 s44, s32, 2162688
    ds_read_b64_tr_b16 v[244:245], v6 offset:18432
    ds_read_b64_tr_b16 v[246:247], v6 offset:18944
    buffer_load_dwordx4 v9, s[8:11], s44 offen lds
    v_mfma_f32_32x32x16_bf16 v[112:127], v[228:231], a[68:71], v[112:127]
    v_cvt_pk_bf16_f32 v40, v30, v31
    v_fma_f32 v32, v158, v94, v158
    v_fma_f32 v33, v159, v95, v159
    ds_read_b64_tr_b16 v[224:225], v6 offset:20480
    ds_read_b64_tr_b16 v[226:227], v6 offset:20992
    s_waitcnt lgkmcnt(6)
    v_mfma_f32_32x32x16_bf16 v[112:127], v[232:235], a[72:75], v[112:127]
    v_cvt_pk_bf16_f32 v41, v32, v33
    ds_read_b64_tr_b16 v[228:229], v6 offset:22528
    ds_read_b64_tr_b16 v[230:231], v6 offset:23040
    buffer_load_dwordx4 v10, s[8:11], s44 offen offset:1024 lds
    v_mfma_f32_32x32x16_bf16 v[112:127], v[236:239], a[76:79], v[112:127]
    s_cmp_lg_u32 s76, 0
    s_cbranch_scc0 L_ss0_1
    buffer_store_dwordx4 v[34:37], v1, s[20:23], s48 offen offset:2048
    buffer_store_dwordx4 v[38:41], v1, s[20:23], s48 offen offset:3072
L_sj0_1:
    ds_read_b64_tr_b16 v[232:233], v6 offset:24576
    ds_read_b64_tr_b16 v[234:235], v6 offset:25088
    s_waitcnt lgkmcnt(6)
    v_mfma_f32_32x32x16_bf16 v[112:127], v[240:243], a[80:83], v[112:127]
    v_mov_b32 v200, v34
    ds_read_b64_tr_b16 v[236:237], v6 offset:26624
    ds_read_b64_tr_b16 v[238:239], v6 offset:27136
    buffer_load_dwordx4 v11, s[8:11], s44 offen offset:2048 lds
    v_mfma_f32_32x32x16_bf16 v[112:127], v[244:247], a[84:87], v[112:127]
    v_mov_b32 v201, v35
    v_mov_b32 v202, v36
    ds_read_b64_tr_b16 v[240:241], v6 offset:28672
    ds_read_b64_tr_b16 v[242:243], v6 offset:29184
    s_waitcnt lgkmcnt(6)
    v_mfma_f32_32x32x16_bf16 v[112:127], v[224:227], a[88:91], v[112:127]
    v_mov_b32 v203, v37
    ds_read_b64_tr_b16 v[244:245], v6 offset:30720
    ds_read_b64_tr_b16 v[246:247], v6 offset:31232
    buffer_load_dwordx4 v12, s[8:11], s44 offen offset:3072 lds
    v_mfma_f32_32x32x16_bf16 v[112:127], v[228:231], a[92:95], v[112:127]
    s_waitcnt vmcnt(10)
    v_mov_b32 v47, 1
    s_cmp_lg_u32 s76, 0
    s_cbranch_scc0 L_fs0_0
    buffer_store_dword v47, v13, s[20:23], 0 offen offset:0
L_fj0_0:
    ds_read_b64_tr_b16 v[224:225], v5 offset:32768
    ds_read_b64_tr_b16 v[226:227], v5 offset:33280
    s_waitcnt lgkmcnt(6)
    v_mfma_f32_32x32x16_bf16 v[112:127], v[232:235], a[96:99], v[112:127]
    v_mov_b32 v204, v38
    s_add_u32 m0, s42, 36864
    s_add_u32 s44, s33, 2162688
    ds_read_b64_tr_b16 v[228:229], v5 offset:34816
    ds_read_b64_tr_b16 v[230:231], v5 offset:35328
    buffer_load_dwordx4 v9, s[8:11], s44 offen lds
    v_mfma_f32_32x32x16_bf16 v[112:127], v[236:239], a[100:103], v[112:127]
    v_mov_b32 v205, v39
    v_mov_b32 v206, v40
    ds_read_b64_tr_b16 v[232:233], v5 offset:36864
    ds_read_b64_tr_b16 v[234:235], v5 offset:37376
    s_waitcnt lgkmcnt(6)
    v_mfma_f32_32x32x16_bf16 v[112:127], v[240:243], a[104:107], v[112:127]
    v_mov_b32 v207, v41
    ds_read_b64_tr_b16 v[236:237], v5 offset:38912
    ds_read_b64_tr_b16 v[238:239], v5 offset:39424
    buffer_load_dwordx4 v10, s[8:11], s44 offen offset:1024 lds
    v_mfma_f32_32x32x16_bf16 v[112:127], v[244:247], a[108:111], v[112:127]
    ds_read_b64_tr_b16 v[240:241], v5 offset:40960
    ds_read_b64_tr_b16 v[242:243], v5 offset:41472
    s_waitcnt lgkmcnt(6)
    v_mfma_f32_32x32x16_bf16 v[96:111], v[224:227], v[208:211], v[96:111]
    ds_read_b64_tr_b16 v[244:245], v5 offset:43008
    ds_read_b64_tr_b16 v[246:247], v5 offset:43520
    buffer_load_dwordx4 v11, s[8:11], s44 offen offset:2048 lds
    v_mfma_f32_32x32x16_bf16 v[96:111], v[228:231], v[212:215], v[96:111]
    ds_read_b64_tr_b16 v[224:225], v5 offset:45056
    ds_read_b64_tr_b16 v[226:227], v5 offset:45568
    s_waitcnt lgkmcnt(6)
    v_mfma_f32_32x32x16_bf16 v[96:111], v[232:235], a[112:115], v[96:111]
    ds_read_b64_tr_b16 v[228:229], v5 offset:47104
    ds_read_b64_tr_b16 v[230:231], v5 offset:47616
    buffer_load_dwordx4 v12, s[8:11], s44 offen offset:3072 lds
    v_mfma_f32_32x32x16_bf16 v[96:111], v[236:239], a[116:119], v[96:111]
    ds_read_b64_tr_b16 v[232:233], v5 offset:49152
    ds_read_b64_tr_b16 v[234:235], v5 offset:49664
    s_waitcnt lgkmcnt(6)
    v_mfma_f32_32x32x16_bf16 v[96:111], v[240:243], a[120:123], v[96:111]
    ds_read_b64_tr_b16 v[236:237], v5 offset:51200
    ds_read_b64_tr_b16 v[238:239], v5 offset:51712
    v_mfma_f32_32x32x16_bf16 v[96:111], v[244:247], a[124:127], v[96:111]
    ds_read_b64_tr_b16 v[240:241], v5 offset:53248
    ds_read_b64_tr_b16 v[242:243], v5 offset:53760
    s_waitcnt lgkmcnt(6)
    v_mfma_f32_32x32x16_bf16 v[96:111], v[224:227], a[128:131], v[96:111]
    ds_read_b64_tr_b16 v[244:245], v5 offset:55296
    ds_read_b64_tr_b16 v[246:247], v5 offset:55808
    v_mfma_f32_32x32x16_bf16 v[96:111], v[228:231], a[132:135], v[96:111]
    s_waitcnt vmcnt(7)
    v_mov_b32 v47, 1
    s_cmp_lg_u32 s76, 0
    s_cbranch_scc0 L_fs0_1
    buffer_store_dword v47, v13, s[20:23], 0 offen offset:32
L_fj0_1:
    ds_read_b64_tr_b16 v[224:225], v5 offset:57344
    ds_read_b64_tr_b16 v[226:227], v5 offset:57856
    s_waitcnt lgkmcnt(6)
    v_mfma_f32_32x32x16_bf16 v[96:111], v[232:235], a[136:139], v[96:111]
    ds_read_b64_tr_b16 v[228:229], v5 offset:59392
    ds_read_b64_tr_b16 v[230:231], v5 offset:59904
    v_mfma_f32_32x32x16_bf16 v[96:111], v[236:239], a[140:143], v[96:111]
    ds_read_b64_tr_b16 v[232:233], v5 offset:61440
    ds_read_b64_tr_b16 v[234:235], v5 offset:61952
    s_waitcnt lgkmcnt(6)
    v_mfma_f32_32x32x16_bf16 v[96:111], v[240:243], a[144:147], v[96:111]
    ds_read_b64_tr_b16 v[236:237], v5 offset:63488
    ds_read_b64_tr_b16 v[238:239], v5 offset:64000
    v_mfma_f32_32x32x16_bf16 v[96:111], v[244:247], a[148:151], v[96:111]
    ds_read_b64_tr_b16 v[240:241], v6 offset:32768
    ds_read_b64_tr_b16 v[242:243], v6 offset:33280
    s_waitcnt lgkmcnt(6)
    v_mfma_f32_32x32x16_bf16 v[96:111], v[224:227], a[152:155], v[96:111]
    ds_read_b64_tr_b16 v[244:245], v6 offset:34816
    ds_read_b64_tr_b16 v[246:247], v6 offset:35328
    v_mfma_f32_32x32x16_bf16 v[96:111], v[228:231], a[156:159], v[96:111]
    ds_read_b64_tr_b16 v[224:225], v6 offset:36864
    ds_read_b64_tr_b16 v[226:227], v6 offset:37376
    s_waitcnt lgkmcnt(6)
    v_mfma_f32_32x32x16_bf16 v[96:111], v[232:235], a[160:163], v[96:111]
    ds_read_b64_tr_b16 v[228:229], v6 offset:38912
    ds_read_b64_tr_b16 v[230:231], v6 offset:39424
    v_mfma_f32_32x32x16_bf16 v[96:111], v[236:239], a[164:167], v[96:111]
    buffer_load_ushort v16, v24, s[12:15], s46 offen offset:0
    ds_read_b64_tr_b16 v[232:233], v6 offset:40960
    ds_read_b64_tr_b16 v[234:235], v6 offset:41472
    s_waitcnt lgkmcnt(6)
    v_mfma_f32_32x32x16_bf16 v[112:127], v[240:243], v[208:211], v[112:127]
    ds_read_b64_tr_b16 v[236:237], v6 offset:43008
    ds_read_b64_tr_b16 v[238:239], v6 offset:43520
    v_mfma_f32_32x32x16_bf16 v[112:127], v[244:247], v[212:215], v[112:127]
    buffer_load_ushort v20, v24, s[12:15], s46 offen offset:64
    s_barrier
    ds_read_b64_tr_b16 v[240:241], v6 offset:45056
    ds_read_b64_tr_b16 v[242:243], v6 offset:45568
    s_waitcnt lgkmcnt(6)
    v_mfma_f32_32x32x16_bf16 v[112:127], v[224:227], a[112:115], v[112:127]
    s_add_u32 m0, s42, 65536
    s_add_u32 s44, s32, 2097280
    ds_read_b64_tr_b16 v[244:245], v6 offset:47104
    ds_read_b64_tr_b16 v[246:247], v6 offset:47616
    buffer_load_dwordx4 v9, s[8:11], s44 offen lds
    v_mfma_f32_32x32x16_bf16 v[112:127], v[228:231], a[116:119], v[112:127]
    ds_read_b64_tr_b16 v[224:225], v6 offset:49152
    ds_read_b64_tr_b16 v[226:227], v6 offset:49664
    s_waitcnt lgkmcnt(6)
    v_mfma_f32_32x32x16_bf16 v[112:127], v[232:235], a[120:123], v[112:127]
    ds_read_b64_tr_b16 v[228:229], v6 offset:51200
    ds_read_b64_tr_b16 v[230:231], v6 offset:51712
    buffer_load_dwordx4 v10, s[8:11], s44 offen offset:1024 lds
    v_mfma_f32_32x32x16_bf16 v[112:127], v[236:239], a[124:127], v[112:127]
    buffer_load_dword v15, v14, s[20:23], 0 offen offset:0 sc1
    ds_read_b64_tr_b16 v[232:233], v6 offset:53248
    ds_read_b64_tr_b16 v[234:235], v6 offset:53760
    s_waitcnt lgkmcnt(6)
    v_mfma_f32_32x32x16_bf16 v[112:127], v[240:243], a[128:131], v[112:127]
    ds_read_b64_tr_b16 v[236:237], v6 offset:55296
    ds_read_b64_tr_b16 v[238:239], v6 offset:55808
    buffer_load_dwordx4 v11, s[8:11], s44 offen offset:2048 lds
    v_mfma_f32_32x32x16_bf16 v[112:127], v[244:247], a[132:135], v[112:127]
    ds_read_b64_tr_b16 v[240:241], v6 offset:57344
    ds_read_b64_tr_b16 v[242:243], v6 offset:57856
    s_waitcnt lgkmcnt(6)
    v_mfma_f32_32x32x16_bf16 v[112:127], v[224:227], a[136:139], v[112:127]
    ds_read_b64_tr_b16 v[244:245], v6 offset:59392
    ds_read_b64_tr_b16 v[246:247], v6 offset:59904
    buffer_load_dwordx4 v12, s[8:11], s44 offen offset:3072 lds
    v_mfma_f32_32x32x16_bf16 v[112:127], v[228:231], a[140:143], v[112:127]
    ds_read_b64_tr_b16 v[224:225], v6 offset:61440
    ds_read_b64_tr_b16 v[226:227], v6 offset:61952
    s_waitcnt lgkmcnt(6)
    v_mfma_f32_32x32x16_bf16 v[112:127], v[232:235], a[144:147], v[112:127]
    s_add_u32 m0, s42, 69632
    s_add_u32 s44, s33, 2097280
    ds_read_b64_tr_b16 v[228:229], v6 offset:63488
    ds_read_b64_tr_b16 v[230:231], v6 offset:64000
    buffer_load_dwordx4 v9, s[8:11], s44 offen lds
    v_mfma_f32_32x32x16_bf16 v[112:127], v[236:239], a[148:151], v[112:127]
    ds_read_b64_tr_b16 v[232:233], v7 offset:0
    ds_read_b64_tr_b16 v[234:235], v7 offset:512
    s_waitcnt lgkmcnt(6)
    v_mfma_f32_32x32x16_bf16 v[112:127], v[240:243], a[152:155], v[112:127]
    ds_read_b64_tr_b16 v[236:237], v7 offset:2048
    ds_read_b64_tr_b16 v[238:239], v7 offset:2560
    buffer_load_dwordx4 v10, s[8:11], s44 offen offset:1024 lds
    v_mfma_f32_32x32x16_bf16 v[112:127], v[244:247], a[156:159], v[112:127]
    ds_read_b64_tr_b16 v[240:241], v7 offset:4096
    ds_read_b64_tr_b16 v[242:243], v7 offset:4608
    s_waitcnt lgkmcnt(6)
    v_mfma_f32_32x32x16_bf16 v[112:127], v[224:227], a[160:163], v[112:127]
    ds_read_b64_tr_b16 v[244:245], v7 offset:6144
    ds_read_b64_tr_b16 v[246:247], v7 offset:6656
    buffer_load_dwordx4 v11, s[8:11], s44 offen offset:2048 lds
    v_mfma_f32_32x32x16_bf16 v[112:127], v[228:231], a[164:167], v[112:127]
    ds_read_b64_tr_b16 v[224:225], v7 offset:8192
    ds_read_b64_tr_b16 v[226:227], v7 offset:8704
    s_waitcnt lgkmcnt(6)
    v_mfma_f32_32x32x16_bf16 v[96:111], v[232:235], v[216:219], v[96:111]
    ds_read_b64_tr_b16 v[228:229], v7 offset:10240
    ds_read_b64_tr_b16 v[230:231], v7 offset:10752
    buffer_load_dwordx4 v12, s[8:11], s44 offen offset:3072 lds
    v_mfma_f32_32x32x16_bf16 v[96:111], v[236:239], v[220:223], v[96:111]
    ds_read_b64_tr_b16 v[232:233], v7 offset:12288
    ds_read_b64_tr_b16 v[234:235], v7 offset:12800
    s_waitcnt lgkmcnt(6)
    v_mfma_f32_32x32x16_bf16 v[96:111], v[240:243], a[168:171], v[96:111]
    ds_read_b64_tr_b16 v[236:237], v7 offset:14336
    ds_read_b64_tr_b16 v[238:239], v7 offset:14848
    v_mfma_f32_32x32x16_bf16 v[96:111], v[244:247], a[172:175], v[96:111]
    ds_read_b64_tr_b16 v[240:241], v7 offset:16384
    ds_read_b64_tr_b16 v[242:243], v7 offset:16896
    s_waitcnt lgkmcnt(6)
    v_mfma_f32_32x32x16_bf16 v[96:111], v[224:227], a[176:179], v[96:111]
    ds_read_b64_tr_b16 v[244:245], v7 offset:18432
    ds_read_b64_tr_b16 v[246:247], v7 offset:18944
    v_mfma_f32_32x32x16_bf16 v[96:111], v[228:231], a[180:183], v[96:111]
    s_waitcnt vmcnt(6)
    v_cmp_gt_u32 s[60:61], 1, v15
    s_nop 3
    s_cmp_lg_u64 s[60:61], 0
    s_cbranch_scc1 L_slow1
L_back1:
    ds_read_b64_tr_b16 v[224:225], v7 offset:20480
    ds_read_b64_tr_b16 v[226:227], v7 offset:20992
    s_waitcnt lgkmcnt(6)
    v_mfma_f32_32x32x16_bf16 v[96:111], v[232:235], a[184:187], v[96:111]
    s_add_u32 s50, s35, 16777216
    ds_read_b64_tr_b16 v[228:229], v7 offset:22528
    ds_read_b64_tr_b16 v[230:231], v7 offset:23040
    buffer_load_dwordx4 a[0:3], v1, s[20:23], s50 offen offset:0 sc1
    v_mfma_f32_32x32x16_bf16 v[96:111], v[236:239], a[188:191], v[96:111]
    ds_read_b64_tr_b16 v[232:233], v7 offset:24576
    ds_read_b64_tr_b16 v[234:235], v7 offset:25088
    s_waitcnt lgkmcnt(6)
    v_mfma_f32_32x32x16_bf16 v[96:111], v[240:243], a[192:195], v[96:111]
    ds_read_b64_tr_b16 v[236:237], v7 offset:26624
    ds_read_b64_tr_b16 v[238:239], v7 offset:27136
    buffer_load_dwordx4 a[4:7], v1, s[20:23], s50 offen offset:1024 sc1
    v_mfma_f32_32x32x16_bf16 v[96:111], v[244:247], a[196:199], v[96:111]
    ds_read_b64_tr_b16 v[240:241], v7 offset:28672
    ds_read_b64_tr_b16 v[242:243], v7 offset:29184
    s_waitcnt lgkmcnt(6)
    v_mfma_f32_32x32x16_bf16 v[96:111], v[224:227], a[200:203], v[96:111]
    s_add_u32 s50, s36, 16777216
    ds_read_b64_tr_b16 v[244:245], v7 offset:30720
    ds_read_b64_tr_b16 v[246:247], v7 offset:31232
    buffer_load_dwordx4 a[8:11], v1, s[20:23], s50 offen offset:0 sc1
    v_mfma_f32_32x32x16_bf16 v[96:111], v[228:231], a[204:207], v[96:111]
    ds_read_b64_tr_b16 v[224:225], v8 offset:0
    ds_read_b64_tr_b16 v[226:227], v8 offset:512
    s_waitcnt lgkmcnt(6)
    v_mfma_f32_32x32x16_bf16 v[96:111], v[232:235], a[208:211], v[96:111]
    ds_read_b64_tr_b16 v[228:229], v8 offset:2048
    ds_read_b64_tr_b16 v[230:231], v8 offset:2560
    buffer_load_dwordx4 a[12:15], v1, s[20:23], s50 offen offset:1024 sc1
    v_mfma_f32_32x32x16_bf16 v[96:111], v[236:239], a[212:215], v[96:111]
    ds_read_b64_tr_b16 v[232:233], v8 offset:4096
    ds_read_b64_tr_b16 v[234:235], v8 offset:4608
    s_waitcnt lgkmcnt(6)
    v_mfma_f32_32x32x16_bf16 v[96:111], v[240:243], a[216:219], v[96:111]
    s_add_u32 s50, s37, 16777216
    ds_read_b64_tr_b16 v[236:237], v8 offset:6144
    ds_read_b64_tr_b16 v[238:239], v8 offset:6656
    buffer_load_dwordx4 a[16:19], v1, s[20:23], s50 offen offset:0 sc1
    v_mfma_f32_32x32x16_bf16 v[96:111], v[244:247], a[220:223], v[96:111]
    ds_read_b64_tr_b16 v[240:241], v8 offset:8192
    ds_read_b64_tr_b16 v[242:243], v8 offset:8704
    s_waitcnt lgkmcnt(6)
    v_mfma_f32_32x32x16_bf16 v[112:127], v[224:227], v[216:219], v[112:127]
    ds_read_b64_tr_b16 v[244:245], v8 offset:10240
    ds_read_b64_tr_b16 v[246:247], v8 offset:10752
    buffer_load_dwordx4 a[20:23], v1, s[20:23], s50 offen offset:1024 sc1
    v_mfma_f32_32x32x16_bf16 v[112:127], v[228:231], v[220:223], v[112:127]
    s_barrier
    ds_read_b64_tr_b16 v[224:225], v8 offset:12288
    ds_read_b64_tr_b16 v[226:227], v8 offset:12800
    s_waitcnt lgkmcnt(6)
    v_mfma_f32_32x32x16_bf16 v[112:127], v[232:235], a[168:171], v[112:127]
    s_add_u32 s50, s38, 16777216
    ds_read_b64_tr_b16 v[228:229], v8 offset:14336
    ds_read_b64_tr_b16 v[230:231], v8 offset:14848
    buffer_load_dwordx4 a[24:27], v1, s[20:23], s50 offen offset:0 sc1
    v_mfma_f32_32x32x16_bf16 v[112:127], v[236:239], a[172:175], v[112:127]
    v_fma_f32 v26, v160, v96, v160
    v_fma_f32 v27, v161, v97, v161
    v_cvt_pk_bf16_f32 v208, v26, v27
    ds_read_b64_tr_b16 v[232:233], v8 offset:16384
    ds_read_b64_tr_b16 v[234:235], v8 offset:16896
    s_waitcnt lgkmcnt(6)
    v_mfma_f32_32x32x16_bf16 v[112:127], v[240:243], a[176:179], v[112:127]
    v_fma_f32 v28, v162, v98, v162
    v_fma_f32 v29, v163, v99, v163
    ds_read_b64_tr_b16 v[236:237], v8 offset:18432
    ds_read_b64_tr_b16 v[238:239], v8 offset:18944
    buffer_load_dwordx4 a[28:31], v1, s[20:23], s50 offen offset:1024 sc1
    v_mfma_f32_32x32x16_bf16 v[112:127], v[244:247], a[180:183], v[112:127]
    v_cvt_pk_bf16_f32 v209, v28, v29
    v_fma_f32 v30, v164, v100, v164
    v_fma_f32 v31, v165, v101, v165
    buffer_load_dword v15, v14, s[20:23], 0 offen offset:32 sc1
    ds_read_b64_tr_b16 v[240:241], v8 offset:20480
    ds_read_b64_tr_b16 v[242:243], v8 offset:20992
    s_waitcnt lgkmcnt(6)
    v_mfma_f32_32x32x16_bf16 v[112:127], v[224:227], a[184:187], v[112:127]
    v_cvt_pk_bf16_f32 v210, v30, v31
    v_fma_f32 v32, v166, v102, v166
    s_add_u32 s50, s39, 16777216
    ds_read_b64_tr_b16 v[244:245], v8 offset:22528
    ds_read_b64_tr_b16 v[246:247], v8 offset:23040
    buffer_load_dwordx4 a[32:35], v1, s[20:23], s50 offen offset:0 sc1
    v_mfma_f32_32x32x16_bf16 v[112:127], v[228:231], a[188:191], v[112:127]
    v_fma_f32 v33, v167, v103, v167
    v_cvt_pk_bf16_f32 v211, v32, v33
    v_fma_f32 v26, v168, v104, v168
    ds_read_b64_tr_b16 v[224:225], v8 offset:24576
    ds_read_b64_tr_b16 v[226:227], v8 offset:25088
    s_waitcnt lgkmcnt(6)
    v_mfma_f32_32x32x16_bf16 v[112:127], v[232:235], a[192:195], v[112:127]
    v_fma_f32 v27, v169, v105, v169
    v_cvt_pk_bf16_f32 v212, v26, v27
    ds_read_b64_tr_b16 v[228:229], v8 offset:26624
    ds_read_b64_tr_b16 v[230:231], v8 offset:27136
    buffer_load_dwordx4 a[36:39], v1, s[20:23], s50 offen offset:1024 sc1
    v_mfma_f32_32x32x16_bf16 v[112:127], v[236:239], a[196:199], v[112:127]
    v_fma_f32 v28, v170, v106, v170
    v_fma_f32 v29, v171, v107, v171
    v_cvt_pk_bf16_f32 v213, v28, v29
    ds_read_b64_tr_b16 v[232:233], v8 offset:28672
    ds_read_b64_tr_b16 v[234:235], v8 offset:29184
    s_waitcnt lgkmcnt(6)
    v_mfma_f32_32x32x16_bf16 v[112:127], v[240:243], a[200:203], v[112:127]
    v_fma_f32 v30, v172, v108, v172
    v_fma_f32 v31, v173, v109, v173
    s_add_u32 s50, s40, 16777216
    ds_read_b64_tr_b16 v[236:237], v8 offset:30720
    ds_read_b64_tr_b16 v[238:239], v8 offset:31232
    buffer_load_dwordx4 a[40:43], v1, s[20:23], s50 offen offset:0 sc1
    v_mfma_f32_32x32x16_bf16 v[112:127], v[244:247], a[204:207], v[112:127]
    v_cvt_pk_bf16_f32 v214, v30, v31
    v_fma_f32 v32, v174, v110, v174
    v_fma_f32 v33, v175, v111, v175
    v_lshrrev_b32 v46, 5, v0
    v_lshlrev_b32 v46, 9, v46
    v_sub_u32 v3, v3, v46
    v_sub_u32 v4, v4, v46
    v_sub_u32 v5, v5, v46
    v_sub_u32 v6, v6, v46
    v_sub_u32 v7, v7, v46
    v_sub_u32 v8, v8, v46
    ds_read_b64_tr_b16 v[240:241], v3 offset:0
    ds_read_b64_tr_b16 v[242:243], v3 offset:1024
    s_waitcnt lgkmcnt(6)
    v_mfma_f32_32x32x16_bf16 v[112:127], v[224:227], a[208:211], v[112:127]
    v_cvt_pk_bf16_f32 v215, v32, v33
    ds_read_b64_tr_b16 v[244:245], v3 offset:2048
    ds_read_b64_tr_b16 v[246:247], v3 offset:3072
    buffer_load_dwordx4 a[44:47], v1, s[20:23], s50 offen offset:1024 sc1
    v_mfma_f32_32x32x16_bf16 v[112:127], v[228:231], a[212:215], v[112:127]
    s_cmp_lg_u32 s76, 0
    s_cbranch_scc0 L_ss0_2
    buffer_store_dwordx4 v[208:211], v2, s[20:23], s48 offen offset:0
    buffer_store_dwordx4 v[212:215], v2, s[20:23], s48 offen offset:1024
L_sj0_2:
    ds_read_b64_tr_b16 v[224:225], v4 offset:0
    ds_read_b64_tr_b16 v[226:227], v4 offset:1024
    s_waitcnt lgkmcnt(6)
    v_mfma_f32_32x32x16_bf16 v[112:127], v[232:235], a[216:219], v[112:127]
    s_add_u32 s50, s41, 16777216
    ds_read_b64_tr_b16 v[228:229], v4 offset:2048
    ds_read_b64_tr_b16 v[230:231], v4 offset:3072
    buffer_load_dwordx4 a[48:51], v1, s[20:23], s50 offen offset:0 sc1
    v_mfma_f32_32x32x16_bf16 v[112:127], v[236:239], a[220:223], v[112:127]
    v_mfma_f32_32x32x16_bf16 v[64:79], v[16:19], v[56:59], 0
    ds_read_b64_tr_b16 v[232:233], v3 offset:4096
    ds_read_b64_tr_b16 v[234:235], v3 offset:5120
    s_waitcnt lgkmcnt(6)
    v_mfma_f32_32x32x16_bf16 v[64:79], v[240:243], v[192:195], v[64:79]
    ds_read_b64_tr_b16 v[236:237], v3 offset:6144
    ds_read_b64_tr_b16 v[238:239], v3 offset:7168
    buffer_load_dwordx4 a[52:55], v1, s[20:23], s50 offen offset:1024 sc1
    v_mfma_f32_32x32x16_bf16 v[64:79], v[244:247], v[196:199], v[64:79]
    v_mfma_f32_32x32x16_bf16 v[80:95], v[20:23], v[56:59], 0
    ds_read_b64_tr_b16 v[240:241], v4 offset:4096
    ds_read_b64_tr_b16 v[242:243], v4 offset:5120
    s_waitcnt lgkmcnt(6)
    v_mfma_f32_32x32x16_bf16 v[80:95], v[224:227], v[192:195], v[80:95]
    s_add_u32 m0, s42, 98304
    s_add_u32 s44, s32, 2228224
    ds_read_b64_tr_b16 v[244:245], v4 offset:6144
    ds_read_b64_tr_b16 v[246:247], v4 offset:7168
    buffer_load_dwordx4 v9, s[8:11], s44 offen lds
    v_mfma_f32_32x32x16_bf16 v[80:95], v[228:231], v[196:199], v[80:95]
    v_fma_f32 v26, v176, v112, v176
    v_fma_f32 v27, v177, v113, v177
    v_cvt_pk_bf16_f32 v216, v26, v27
    ds_read_b64_tr_b16 v[224:225], v3 offset:8192
    ds_read_b64_tr_b16 v[226:227], v3 offset:9216
    s_waitcnt vmcnt(16) lgkmcnt(6)
    v_mfma_f32_32x32x16_bf16 v[64:79], v[232:235], a[0:3], v[64:79]
    v_fma_f32 v28, v178, v114, v178
    v_fma_f32 v29, v179, v115, v179
    ds_read_b64_tr_b16 v[228:229], v3 offset:10240
    ds_read_b64_tr_b16 v[230:231], v3 offset:11264
    buffer_load_dwordx4 v10, s[8:11], s44 offen offset:1024 lds
    v_mfma_f32_32x32x16_bf16 v[64:79], v[236:239], a[4:7], v[64:79]
    v_cvt_pk_bf16_f32 v217, v28, v29
    v_fma_f32 v30, v180, v116, v180
    v_fma_f32 v31, v181, v117, v181
    s_waitcnt vmcnt(10)
    v_cmp_gt_u32 s[60:61], 1, v15
    s_nop 3
    s_cmp_lg_u64 s[60:61], 0
    s_cbranch_scc1 L_slow2
L_back2:
    ds_read_b64_tr_b16 v[232:233], v4 offset:8192
    ds_read_b64_tr_b16 v[234:235], v4 offset:9216
    s_waitcnt lgkmcnt(6)
    v_mfma_f32_32x32x16_bf16 v[80:95], v[240:243], a[0:3], v[80:95]
    v_cvt_pk_bf16_f32 v218, v30, v31
    v_fma_f32 v32, v182, v118, v182
    s_add_u32 s50, s35, 16777216
    ds_read_b64_tr_b16 v[236:237], v4 offset:10240
    ds_read_b64_tr_b16 v[238:239], v4 offset:11264
    buffer_load_dwordx4 a[56:59], v1, s[20:23], s50 offen offset:2048 sc1
    v_mfma_f32_32x32x16_bf16 v[80:95], v[244:247], a[4:7], v[80:95]
    v_fma_f32 v33, v183, v119, v183
    v_cvt_pk_bf16_f32 v219, v32, v33
    v_fma_f32 v26, v184, v120, v184
    ds_read_b64_tr_b16 v[240:241], v3 offset:12288
    ds_read_b64_tr_b16 v[242:243], v3 offset:13312
    s_waitcnt lgkmcnt(6)
    v_mfma_f32_32x32x16_bf16 v[64:79], v[224:227], a[8:11], v[64:79]
    v_fma_f32 v27, v185, v121, v185
    v_cvt_pk_bf16_f32 v220, v26, v27
    ds_read_b64_tr_b16 v[244:245], v3 offset:14336
    ds_read_b64_tr_b16 v[246:247], v3 offset:15360
    buffer_load_dwordx4 a[60:63], v1, s[20:23], s50 offen offset:3072 sc1
    v_mfma_f32_32x32x16_bf16 v[64:79], v[228:231], a[12:15], v[64:79]
    v_fma_f32 v28, v186, v122, v186
    v_fma_f32 v29, v187, v123, v187
    v_cvt_pk_bf16_f32 v221, v28, v29
    ds_read_b64_tr_b16 v[224:225], v4 offset:12288
    ds_read_b64_tr_b16 v[226:227], v4 offset:13312
    s_waitcnt lgkmcnt(6)
    v_mfma_f32_32x32x16_bf16 v[80:95], v[232:235], a[8:11], v[80:95]
    v_fma_f32 v30, v188, v124, v188
    v_fma_f32 v31, v189, v125, v189
    s_add_u32 s50, s36, 16777216
    ds_read_b64_tr_b16 v[228:229], v4 offset:14336
    ds_read_b64_tr_b16 v[230:231], v4 offset:15360
    buffer_load_dwordx4 a[64:67], v1, s[20:23], s50 offen offset:2048 sc1
    v_mfma_f32_32x32x16_bf16 v[80:95], v[236:239], a[12:15], v[80:95]
    v_cvt_pk_bf16_f32 v222, v30, v31
    v_fma_f32 v32, v190, v126, v190
    v_fma_f32 v33, v191, v127, v191
    ds_read_b64_tr_b16 v[232:233], v3 offset:16384
    ds_read_b64_tr_b16 v[234:235], v3 offset:17408
    s_waitcnt lgkmcnt(6)
    v_mfma_f32_32x32x16_bf16 v[64:79], v[240:243], a[16:19], v[64:79]
    v_cvt_pk_bf16_f32 v223, v32, v33
    ds_read_b64_tr_b16 v[236:237], v3 offset:18432
    ds_read_b64_tr_b16 v[238:239], v3 offset:19456
    buffer_load_dwordx4 a[68:71], v1, s[20:23], s50 offen offset:3072 sc1
    v_mfma_f32_32x32x16_bf16 v[64:79], v[244:247], a[20:23], v[64:79]
    s_waitcnt vmcnt(8)
    v_mov_b32 v47, 1
    s_cmp_lg_u32 s76, 0
    s_cbranch_scc0 L_fs0_2
    buffer_store_dword v47, v13, s[20:23], 0 offen offset:64
L_fj0_2:
    s_cmp_lg_u32 s76, 0
    s_cbranch_scc0 L_ss0_3
    buffer_store_dwordx4 v[216:219], v2, s[20:23], s48 offen offset:2048
    buffer_store_dwordx4 v[220:223], v2, s[20:23], s48 offen offset:3072
L_sj0_3:
    ds_read_b64_tr_b16 v[240:241], v4 offset:16384
    ds_read_b64_tr_b16 v[242:243], v4 offset:17408
    s_waitcnt lgkmcnt(6)
    v_mfma_f32_32x32x16_bf16 v[80:95], v[224:227], a[16:19], v[80:95]
    s_add_u32 s50, s37, 16777216
    ds_read_b64_tr_b16 v[244:245], v4 offset:18432
    ds_read_b64_tr_b16 v[246:247], v4 offset:19456
    buffer_load_dwordx4 a[72:75], v1, s[20:23], s50 offen offset:2048 sc1
    v_mfma_f32_32x32x16_bf16 v[80:95], v[228:231], a[20:23], v[80:95]
    buffer_load_ushort v16, v24, s[12:15], s46 offen offset:128
    ds_read_b64_tr_b16 v[224:225], v3 offset:20480
    ds_read_b64_tr_b16 v[226:227], v3 offset:21504
    s_waitcnt lgkmcnt(6)
    v_mfma_f32_32x32x16_bf16 v[64:79], v[232:235], a[24:27], v[64:79]
    ds_read_b64_tr_b16 v[228:229], v3 offset:22528
    ds_read_b64_tr_b16 v[230:231], v3 offset:23552
    buffer_load_dwordx4 a[76:79], v1, s[20:23], s50 offen offset:3072 sc1
    v_mfma_f32_32x32x16_bf16 v[64:79], v[236:239], a[28:31], v[64:79]
    s_barrier
    ds_read_b64_tr_b16 v[232:233], v4 offset:20480
    ds_read_b64_tr_b16 v[234:235], v4 offset:21504
    s_waitcnt lgkmcnt(6)
    v_mfma_f32_32x32x16_bf16 v[80:95], v[240:243], a[24:27], v[80:95]
    s_add_u32 s50, s38, 16777216
    ds_read_b64_tr_b16 v[236:237], v4 offset:22528
    ds_read_b64_tr_b16 v[238:239], v4 offset:23552
    buffer_load_dwordx4 a[80:83], v1, s[20:23], s50 offen offset:2048 sc1
    v_mfma_f32_32x32x16_bf16 v[80:95], v[244:247], a[28:31], v[80:95]
    ds_read_b64_tr_b16 v[240:241], v3 offset:24576
    ds_read_b64_tr_b16 v[242:243], v3 offset:25600
    s_waitcnt lgkmcnt(6)
    v_mfma_f32_32x32x16_bf16 v[64:79], v[224:227], a[32:35], v[64:79]
    ds_read_b64_tr_b16 v[244:245], v3 offset:26624
    ds_read_b64_tr_b16 v[246:247], v3 offset:27648
    buffer_load_dwordx4 a[84:87], v1, s[20:23], s50 offen offset:3072 sc1
    v_mfma_f32_32x32x16_bf16 v[64:79], v[228:231], a[36:39], v[64:79]
    ds_read_b64_tr_b16 v[224:225], v4 offset:24576
    ds_read_b64_tr_b16 v[226:227], v4 offset:25600
    s_waitcnt lgkmcnt(6)
    v_mfma_f32_32x32x16_bf16 v[80:95], v[232:235], a[32:35], v[80:95]
    ds_read_b64_tr_b16 v[228:229], v4 offset:26624
    ds_read_b64_tr_b16 v[230:231], v4 offset:27648
    buffer_load_dwordx4 v11, s[8:11], s44 offen offset:2048 lds
    v_mfma_f32_32x32x16_bf16 v[80:95], v[236:239], a[36:39], v[80:95]
    ds_read_b64_tr_b16 v[232:233], v3 offset:28672
    ds_read_b64_tr_b16 v[234:235], v3 offset:29696
    s_waitcnt lgkmcnt(6)
    v_mfma_f32_32x32x16_bf16 v[64:79], v[240:243], a[40:43], v[64:79]
    ds_read_b64_tr_b16 v[236:237], v3 offset:30720
    ds_read_b64_tr_b16 v[238:239], v3 offset:31744
    buffer_load_dwordx4 v12, s[8:11], s44 offen offset:3072 lds
    v_mfma_f32_32x32x16_bf16 v[64:79], v[244:247], a[44:47], v[64:79]
    ds_read_b64_tr_b16 v[240:241], v4 offset:28672
    ds_read_b64_tr_b16 v[242:243], v4 offset:29696
    s_waitcnt lgkmcnt(6)
    v_mfma_f32_32x32x16_bf16 v[80:95], v[224:227], a[40:43], v[80:95]
    s_add_u32 m0, s42, 102400
    s_add_u32 s44, s33, 2228224
    ds_read_b64_tr_b16 v[244:245], v4 offset:30720
    ds_read_b64_tr_b16 v[246:247], v4 offset:31744
    buffer_load_dwordx4 v9, s[8:11], s44 offen lds
    v_mfma_f32_32x32x16_bf16 v[80:95], v[228:231], a[44:47], v[80:95]
    ds_read_b64_tr_b16 v[224:225], v3 offset:32768
    ds_read_b64_tr_b16 v[226:227], v3 offset:33792
    s_waitcnt vmcnt(17) lgkmcnt(6)
    v_mfma_f32_32x32x16_bf16 v[64:79], v[232:235], a[48:51], v[64:79]
    ds_read_b64_tr_b16 v[228:229], v3 offset:34816
    ds_read_b64_tr_b16 v[230:231], v3 offset:35840
    buffer_load_dwordx4 v10, s[8:11], s44 offen offset:1024 lds
    v_mfma_f32_32x32x16_bf16 v[64:79], v[236:239], a[52:55], v[64:79]
    s_waitcnt vmcnt(9)
    v_mov_b32 v47, 1
    s_cmp_lg_u32 s76, 0
    s_cbranch_scc0 L_fs0_3
    buffer_store_dword v47, v13, s[20:23], 0 offen offset:96
L_fj0_3:
    ds_read_b64_tr_b16 v[232:233], v4 offset:32768
    ds_read_b64_tr_b16 v[234:235], v4 offset:33792
    buffer_load_dwordx4 v11, s[8:11], s44 offen offset:2048 lds
    s_waitcnt lgkmcnt(6)
    v_mfma_f32_32x32x16_bf16 v[80:95], v[240:243], a[48:51], v[80:95]
    ds_read_b64_tr_b16 v[236:237], v4 offset:34816
    ds_read_b64_tr_b16 v[238:239], v4 offset:35840
    buffer_load_dwordx4 v12, s[8:11], s44 offen offset:3072 lds
    v_mfma_f32_32x32x16_bf16 v[80:95], v[244:247], a[52:55], v[80:95]
    buffer_load_ushort v20, v24, s[12:15], s46 offen offset:192
    s_add_u32 s50, s39, 16777216
    ds_read_b64_tr_b16 v[240:241], v3 offset:36864
    ds_read_b64_tr_b16 v[242:243], v3 offset:37888
    buffer_load_dwordx4 a[88:91], v1, s[20:23], s50 offen offset:2048 sc1
    s_waitcnt lgkmcnt(6)
    v_mfma_f32_32x32x16_bf16 v[64:79], v[224:227], v[200:203], v[64:79]
    ds_read_b64_tr_b16 v[244:245], v3 offset:38912
    ds_read_b64_tr_b16 v[246:247], v3 offset:39936
    buffer_load_dwordx4 a[92:95], v1, s[20:23], s50 offen offset:3072 sc1
    v_mfma_f32_32x32x16_bf16 v[64:79], v[228:231], v[204:207], v[64:79]
    s_add_u32 s50, s40, 16777216
    ds_read_b64_tr_b16 v[224:225], v4 offset:36864
    ds_read_b64_tr_b16 v[226:227], v4 offset:37888
    buffer_load_dwordx4 a[96:99], v1, s[20:23], s50 offen offset:2048 sc1
    s_waitcnt lgkmcnt(6)
    v_mfma_f32_32x32x16_bf16 v[80:95], v[232:235], v[200:203], v[80:95]
    ds_read_b64_tr_b16 v[228:229], v4 offset:38912
    ds_read_b64_tr_b16 v[230:231], v4 offset:39936
    buffer_load_dwordx4 a[100:103], v1, s[20:23], s50 offen offset:3072 sc1
    v_mfma_f32_32x32x16_bf16 v[80:95], v[236:239], v[204:207], v[80:95]
    ds_read_b64_tr_b16 v[232:233], v3 offset:40960
    ds_read_b64_tr_b16 v[234:235], v3 offset:41984
    s_waitcnt lgkmcnt(6)
    v_mfma_f32_32x32x16_bf16 v[64:79], v[240:243], a[56:59], v[64:79]
    s_add_u32 s50, s41, 16777216
    ds_read_b64_tr_b16 v[236:237], v3 offset:43008
    ds_read_b64_tr_b16 v[238:239], v3 offset:44032
    buffer_load_dwordx4 a[104:107], v1, s[20:23], s50 offen offset:2048 sc1
    v_mfma_f32_32x32x16_bf16 v[64:79], v[244:247], a[60:63], v[64:79]
    ds_read_b64_tr_b16 v[240:241], v4 offset:40960
    ds_read_b64_tr_b16 v[242:243], v4 offset:41984
    s_waitcnt lgkmcnt(6)
    v_mfma_f32_32x32x16_bf16 v[80:95], v[224:227], a[56:59], v[80:95]
    ds_read_b64_tr_b16 v[244:245], v4 offset:43008
    ds_read_b64_tr_b16 v[246:247], v4 offset:44032
    buffer_load_dwordx4 a[108:111], v1, s[20:23], s50 offen offset:3072 sc1
    v_mfma_f32_32x32x16_bf16 v[80:95], v[228:231], a[60:63], v[80:95]
    ds_read_b64_tr_b16 v[224:225], v3 offset:45056
    ds_read_b64_tr_b16 v[226:227], v3 offset:46080
    s_waitcnt lgkmcnt(6)
    v_mfma_f32_32x32x16_bf16 v[64:79], v[232:235], a[64:67], v[64:79]
    s_add_u32 m0, s42, 131072
    s_add_u32 s44, s32, 2293760
    ds_read_b64_tr_b16 v[228:229], v3 offset:47104
    ds_read_b64_tr_b16 v[230:231], v3 offset:48128
    buffer_load_dwordx4 v9, s[8:11], s44 offen lds
    v_mfma_f32_32x32x16_bf16 v[64:79], v[236:239], a[68:71], v[64:79]
    ds_read_b64_tr_b16 v[232:233], v4 offset:45056
    ds_read_b64_tr_b16 v[234:235], v4 offset:46080
    s_waitcnt lgkmcnt(6)
    v_mfma_f32_32x32x16_bf16 v[80:95], v[240:243], a[64:67], v[80:95]
    ds_read_b64_tr_b16 v[236:237], v4 offset:47104
    ds_read_b64_tr_b16 v[238:239], v4 offset:48128
    buffer_load_dwordx4 v10, s[8:11], s44 offen offset:1024 lds
    v_mfma_f32_32x32x16_bf16 v[80:95], v[244:247], a[68:71], v[80:95]
    ds_read_b64_tr_b16 v[240:241], v3 offset:49152
    ds_read_b64_tr_b16 v[242:243], v3 offset:50176
    s_waitcnt vmcnt(18) lgkmcnt(6)
    v_mfma_f32_32x32x16_bf16 v[64:79], v[224:227], a[72:75], v[64:79]
    ds_read_b64_tr_b16 v[244:245], v3 offset:51200
    ds_read_b64_tr_b16 v[246:247], v3 offset:52224
    buffer_load_dwordx4 v11, s[8:11], s44 offen offset:2048 lds
    v_mfma_f32_32x32x16_bf16 v[64:79], v[228:231], a[76:79], v[64:79]
    ds_read_b64_tr_b16 v[224:225], v4 offset:49152
    ds_read_b64_tr_b16 v[226:227], v4 offset:50176
    s_waitcnt lgkmcnt(6)
    v_mfma_f32_32x32x16_bf16 v[80:95], v[232:235], a[72:75], v[80:95]
    ds_read_b64_tr_b16 v[228:229], v4 offset:51200
    ds_read_b64_tr_b16 v[230:231], v4 offset:52224
    buffer_load_dwordx4 v12, s[8:11], s44 offen offset:3072 lds
    v_mfma_f32_32x32x16_bf16 v[80:95], v[236:239], a[76:79], v[80:95]
    ds_read_b64_tr_b16 v[232:233], v3 offset:53248
    ds_read_b64_tr_b16 v[234:235], v3 offset:54272
    s_waitcnt vmcnt(18) lgkmcnt(6)
    v_mfma_f32_32x32x16_bf16 v[64:79], v[240:243], a[80:83], v[64:79]
    s_add_u32 m0, s42, 135168
    s_add_u32 s44, s33, 2293760
    ds_read_b64_tr_b16 v[236:237], v3 offset:55296
    ds_read_b64_tr_b16 v[238:239], v3 offset:56320
    buffer_load_dwordx4 v9, s[8:11], s44 offen lds
    v_mfma_f32_32x32x16_bf16 v[64:79], v[244:247], a[84:87], v[64:79]
    s_barrier
    ds_read_b64_tr_b16 v[240:241], v4 offset:53248
    ds_read_b64_tr_b16 v[242:243], v4 offset:54272
    s_waitcnt lgkmcnt(6)
    v_mfma_f32_32x32x16_bf16 v[80:95], v[224:227], a[80:83], v[80:95]
    ds_read_b64_tr_b16 v[244:245], v4 offset:55296
    ds_read_b64_tr_b16 v[246:247], v4 offset:56320
    buffer_load_dwordx4 v10, s[8:11], s44 offen offset:1024 lds
    v_mfma_f32_32x32x16_bf16 v[80:95], v[228:231], a[84:87], v[80:95]
    ds_read_b64_tr_b16 v[224:225], v3 offset:57344
    ds_read_b64_tr_b16 v[226:227], v3 offset:58368
    s_waitcnt vmcnt(10) lgkmcnt(6)
    v_mfma_f32_32x32x16_bf16 v[64:79], v[232:235], a[88:91], v[64:79]
    ds_read_b64_tr_b16 v[228:229], v3 offset:59392
    ds_read_b64_tr_b16 v[230:231], v3 offset:60416
    buffer_load_dwordx4 v11, s[8:11], s44 offen offset:2048 lds
    v_mfma_f32_32x32x16_bf16 v[64:79], v[236:239], a[92:95], v[64:79]
    buffer_load_dword v15, v14, s[20:23], 0 offen offset:64 sc1
    ds_read_b64_tr_b16 v[232:233], v4 offset:57344
    ds_read_b64_tr_b16 v[234:235], v4 offset:58368
    s_waitcnt lgkmcnt(6)
    v_mfma_f32_32x32x16_bf16 v[80:95], v[240:243], a[88:91], v[80:95]
    ds_read_b64_tr_b16 v[236:237], v4 offset:59392
    ds_read_b64_tr_b16 v[238:239], v4 offset:60416
    buffer_load_dwordx4 v12, s[8:11], s44 offen offset:3072 lds
    v_mfma_f32_32x32x16_bf16 v[80:95], v[244:247], a[92:95], v[80:95]
    ds_read_b64_tr_b16 v[240:241], v3 offset:61440
    ds_read_b64_tr_b16 v[242:243], v3 offset:62464
    s_waitcnt vmcnt(11) lgkmcnt(6)
    v_mfma_f32_32x32x16_bf16 v[64:79], v[224:227], a[96:99], v[64:79]
    s_add_u32 m0, s42, 0
    s_add_u32 s44, s32, 2162816
    ds_read_b64_tr_b16 v[244:245], v3 offset:63488
    ds_read_b64_tr_b16 v[246:247], v3 offset:64512
    buffer_load_dwordx4 v9, s[8:11], s44 offen lds
    v_mfma_f32_32x32x16_bf16 v[64:79], v[228:231], a[100:103], v[64:79]
    ds_read_b64_tr_b16 v[224:225], v4 offset:61440
    ds_read_b64_tr_b16 v[226:227], v4 offset:62464
    s_waitcnt lgkmcnt(6)
    v_mfma_f32_32x32x16_bf16 v[80:95], v[232:235], a[96:99], v[80:95]
    ds_read_b64_tr_b16 v[228:229], v4 offset:63488
    ds_read_b64_tr_b16 v[230:231], v4 offset:64512
    buffer_load_dwordx4 v10, s[8:11], s44 offen offset:1024 lds
    v_mfma_f32_32x32x16_bf16 v[80:95], v[236:239], a[100:103], v[80:95]
    ds_read_b64_tr_b16 v[232:233], v5 offset:0
    ds_read_b64_tr_b16 v[234:235], v5 offset:1024
    s_waitcnt vmcnt(11) lgkmcnt(6)
    v_mfma_f32_32x32x16_bf16 v[64:79], v[240:243], a[104:107], v[64:79]
    ds_read_b64_tr_b16 v[236:237], v5 offset:2048
    ds_read_b64_tr_b16 v[238:239], v5 offset:3072
    buffer_load_dwordx4 v11, s[8:11], s44 offen offset:2048 lds
    v_mfma_f32_32x32x16_bf16 v[64:79], v[244:247], a[108:111], v[64:79]
    ds_read_b64_tr_b16 v[240:241], v5 offset:4096
    ds_read_b64_tr_b16 v[242:243], v5 offset:5120
    s_waitcnt lgkmcnt(6)
    v_mfma_f32_32x32x16_bf16 v[80:95], v[224:227], a[104:107], v[80:95]
    ds_read_b64_tr_b16 v[244:245], v5 offset:6144
    ds_read_b64_tr_b16 v[246:247], v5 offset:7168
    buffer_load_dwordx4 v12, s[8:11], s44 offen offset:3072 lds
    v_mfma_f32_32x32x16_bf16 v[80:95], v[228:231], a[108:111], v[80:95]
    v_mfma_f32_32x32x16_bf16 v[96:111], v[16:19], v[56:59], 0
    ds_read_b64_tr_b16 v[224:225], v5 offset:8192
    ds_read_b64_tr_b16 v[226:227], v5 offset:9216
    s_waitcnt lgkmcnt(6)
    v_mfma_f32_32x32x16_bf16 v[96:111], v[232:235], v[192:195], v[96:111]
    s_add_u32 m0, s42, 4096
    s_add_u32 s44, s33, 2162816
    ds_read_b64_tr_b16 v[228:229], v5 offset:10240
    ds_read_b64_tr_b16 v[230:231], v5 offset:11264
    buffer_load_dwordx4 v9, s[8:11], s44 offen lds
    v_mfma_f32_32x32x16_bf16 v[96:111], v[236:239], v[196:199], v[96:111]
    ds_read_b64_tr_b16 v[232:233], v5 offset:12288
    ds_read_b64_tr_b16 v[234:235], v5 offset:13312
    s_waitcnt lgkmcnt(6)
    v_mfma_f32_32x32x16_bf16 v[96:111], v[240:243], a[0:3], v[96:111]
    ds_read_b64_tr_b16 v[236:237], v5 offset:14336
    ds_read_b64_tr_b16 v[238:239], v5 offset:15360
    buffer_load_dwordx4 v10, s[8:11], s44 offen offset:1024 lds
    v_mfma_f32_32x32x16_bf16 v[96:111], v[244:247], a[4:7], v[96:111]
    ds_read_b64_tr_b16 v[240:241], v5 offset:16384
    ds_read_b64_tr_b16 v[242:243], v5 offset:17408
    s_waitcnt lgkmcnt(6)
    v_mfma_f32_32x32x16_bf16 v[96:111], v[224:227], a[8:11], v[96:111]
    ds_read_b64_tr_b16 v[244:245], v5 offset:18432
    ds_read_b64_tr_b16 v[246:247], v5 offset:19456
    buffer_load_dwordx4 v11, s[8:11], s44 offen offset:2048 lds
    v_mfma_f32_32x32x16_bf16 v[96:111], v[228:231], a[12:15], v[96:111]
    s_waitcnt vmcnt(8)
    v_cmp_gt_u32 s[60:61], 1, v15
    s_nop 3
    s_cmp_lg_u64 s[60:61], 0
    s_cbranch_scc1 L_slow3
L_back3:
    ds_read_b64_tr_b16 v[224:225], v5 offset:20480
    ds_read_b64_tr_b16 v[226:227], v5 offset:21504
    s_waitcnt lgkmcnt(6)
    v_mfma_f32_32x32x16_bf16 v[96:111], v[232:235], a[16:19], v[96:111]
    s_add_u32 s50, s35, 16777216
    ds_read_b64_tr_b16 v[228:229], v5 offset:22528
    ds_read_b64_tr_b16 v[230:231], v5 offset:23552
    buffer_load_dwordx4 a[112:115], v2, s[20:23], s50 offen offset:0 sc1
    v_mfma_f32_32x32x16_bf16 v[96:111], v[236:239], a[20:23], v[96:111]
    ds_read_b64_tr_b16 v[232:233], v5 offset:24576
    ds_read_b64_tr_b16 v[234:235], v5 offset:25600
    s_waitcnt lgkmcnt(6)
    v_mfma_f32_32x32x16_bf16 v[96:111], v[240:243], a[24:27], v[96:111]
    ds_read_b64_tr_b16 v[236:237], v5 offset:26624
    ds_read_b64_tr_b16 v[238:239], v5 offset:27648
    buffer_load_dwordx4 a[116:119], v2, s[20:23], s50 offen offset:1024 sc1
    v_mfma_f32_32x32x16_bf16 v[96:111], v[244:247], a[28:31], v[96:111]
    ds_read_b64_tr_b16 v[240:241], v5 offset:28672
    ds_read_b64_tr_b16 v[242:243], v5 offset:29696
    s_waitcnt lgkmcnt(6)
    v_mfma_f32_32x32x16_bf16 v[96:111], v[224:227], a[32:35], v[96:111]
    s_add_u32 s50, s36, 16777216
    ds_read_b64_tr_b16 v[244:245], v5 offset:30720
    ds_read_b64_tr_b16 v[246:247], v5 offset:31744
    buffer_load_dwordx4 a[120:123], v2, s[20:23], s50 offen offset:0 sc1
    v_mfma_f32_32x32x16_bf16 v[96:111], v[228:231], a[36:39], v[96:111]
    ds_read_b64_tr_b16 v[224:225], v6 offset:0
    ds_read_b64_tr_b16 v[226:227], v6 offset:1024
    s_waitcnt lgkmcnt(6)
    v_mfma_f32_32x32x16_bf16 v[96:111], v[232:235], a[40:43], v[96:111]
    ds_read_b64_tr_b16 v[228:229], v6 offset:2048
    ds_read_b64_tr_b16 v[230:231], v6 offset:3072
    buffer_load_dwordx4 a[124:127], v2, s[20:23], s50 offen offset:1024 sc1
    v_mfma_f32_32x32x16_bf16 v[96:111], v[236:239], a[44:47], v[96:111]
    ds_read_b64_tr_b16 v[232:233], v6 offset:4096
    ds_read_b64_tr_b16 v[234:235], v6 offset:5120
    s_waitcnt lgkmcnt(6)
    v_mfma_f32_32x32x16_bf16 v[96:111], v[240:243], a[48:51], v[96:111]
    s_add_u32 s50, s37, 16777216
    ds_read_b64_tr_b16 v[236:237], v6 offset:6144
    ds_read_b64_tr_b16 v[238:239], v6 offset:7168
    buffer_load_dwordx4 a[128:131], v2, s[20:23], s50 offen offset:0 sc1
    v_mfma_f32_32x32x16_bf16 v[96:111], v[244:247], a[52:55], v[96:111]
    v_mfma_f32_32x32x16_bf16 v[112:127], v[20:23], v[56:59], 0
    ds_read_b64_tr_b16 v[240:241], v6 offset:8192
    ds_read_b64_tr_b16 v[242:243], v6 offset:9216
    s_waitcnt lgkmcnt(6)
    v_mfma_f32_32x32x16_bf16 v[112:127], v[224:227], v[192:195], v[112:127]
    ds_read_b64_tr_b16 v[244:245], v6 offset:10240
    ds_read_b64_tr_b16 v[246:247], v6 offset:11264
    buffer_load_dwordx4 a[132:135], v2, s[20:23], s50 offen offset:1024 sc1
    v_mfma_f32_32x32x16_bf16 v[112:127], v[228:231], v[196:199], v[112:127]
    s_barrier
    ds_read_b64_tr_b16 v[224:225], v6 offset:12288
    ds_read_b64_tr_b16 v[226:227], v6 offset:13312
    s_waitcnt lgkmcnt(6)
    v_mfma_f32_32x32x16_bf16 v[112:127], v[232:235], a[0:3], v[112:127]
    s_add_u32 s50, s38, 16777216
    ds_read_b64_tr_b16 v[228:229], v6 offset:14336
    ds_read_b64_tr_b16 v[230:231], v6 offset:15360
    buffer_load_dwordx4 a[136:139], v2, s[20:23], s50 offen offset:0 sc1
    v_mfma_f32_32x32x16_bf16 v[112:127], v[236:239], a[4:7], v[112:127]
    ds_read_b64_tr_b16 v[232:233], v6 offset:16384
    ds_read_b64_tr_b16 v[234:235], v6 offset:17408
    s_waitcnt lgkmcnt(6)
    v_mfma_f32_32x32x16_bf16 v[112:127], v[240:243], a[8:11], v[112:127]
    ds_read_b64_tr_b16 v[236:237], v6 offset:18432
    ds_read_b64_tr_b16 v[238:239], v6 offset:19456
    buffer_load_dwordx4 a[140:143], v2, s[20:23], s50 offen offset:1024 sc1
    v_mfma_f32_32x32x16_bf16 v[112:127], v[244:247], a[12:15], v[112:127]
    buffer_load_dword v15, v14, s[20:23], 0 offen offset:96 sc1
    ds_read_b64_tr_b16 v[240:241], v6 offset:20480
    ds_read_b64_tr_b16 v[242:243], v6 offset:21504
    s_waitcnt lgkmcnt(6)
    v_mfma_f32_32x32x16_bf16 v[112:127], v[224:227], a[16:19], v[112:127]
    ds_read_b64_tr_b16 v[244:245], v6 offset:22528
    ds_read_b64_tr_b16 v[246:247], v6 offset:23552
    buffer_load_dwordx4 v12, s[8:11], s44 offen offset:3072 lds
    v_mfma_f32_32x32x16_bf16 v[112:127], v[228:231], a[20:23], v[112:127]
    ds_read_b64_tr_b16 v[224:225], v6 offset:24576
    ds_read_b64_tr_b16 v[226:227], v6 offset:25600
    s_waitcnt lgkmcnt(6)
    v_mfma_f32_32x32x16_bf16 v[112:127], v[232:235], a[24:27], v[112:127]
    s_add_u32 s50, s39, 16777216
    ds_read_b64_tr_b16 v[228:229], v6 offset:26624
    ds_read_b64_tr_b16 v[230:231], v6 offset:27648
    buffer_load_dwordx4 a[144:147], v2, s[20:23], s50 offen offset:0 sc1
    v_mfma_f32_32x32x16_bf16 v[112:127], v[236:239], a[28:31], v[112:127]
    ds_read_b64_tr_b16 v[232:233], v6 offset:28672
    ds_read_b64_tr_b16 v[234:235], v6 offset:29696
    s_waitcnt lgkmcnt(6)
    v_mfma_f32_32x32x16_bf16 v[112:127], v[240:243], a[32:35], v[112:127]
    ds_read_b64_tr_b16 v[236:237], v6 offset:30720
    ds_read_b64_tr_b16 v[238:239], v6 offset:31744
    buffer_load_dwordx4 a[148:151], v2, s[20:23], s50 offen offset:1024 sc1
    v_mfma_f32_32x32x16_bf16 v[112:127], v[244:247], a[36:39], v[112:127]
    ds_read_b64_tr_b16 v[240:241], v5 offset:32768
    ds_read_b64_tr_b16 v[242:243], v5 offset:33792
    s_waitcnt lgkmcnt(6)
    v_mfma_f32_32x32x16_bf16 v[112:127], v[224:227], a[40:43], v[112:127]
    s_add_u32 s50, s40, 16777216
    ds_read_b64_tr_b16 v[244:245], v5 offset:34816
    ds_read_b64_tr_b16 v[246:247], v5 offset:35840
    buffer_load_dwordx4 a[152:155], v2, s[20:23], s50 offen offset:0 sc1
    v_mfma_f32_32x32x16_bf16 v[112:127], v[228:231], a[44:47], v[112:127]
    ds_read_b64_tr_b16 v[224:225], v6 offset:32768
    ds_read_b64_tr_b16 v[226:227], v6 offset:33792
    s_waitcnt lgkmcnt(6)
    v_mfma_f32_32x32x16_bf16 v[112:127], v[232:235], a[48:51], v[112:127]
    ds_read_b64_tr_b16 v[228:229], v6 offset:34816
    ds_read_b64_tr_b16 v[230:231], v6 offset:35840
    buffer_load_dwordx4 a[156:159], v2, s[20:23], s50 offen offset:1024 sc1
    v_mfma_f32_32x32x16_bf16 v[112:127], v[236:239], a[52:55], v[112:127]
    ds_read_b64_tr_b16 v[232:233], v5 offset:36864
    ds_read_b64_tr_b16 v[234:235], v5 offset:37888
    s_waitcnt lgkmcnt(6)
    v_mfma_f32_32x32x16_bf16 v[64:79], v[240:243], v[208:211], v[64:79]
    s_add_u32 s50, s41, 16777216
    ds_read_b64_tr_b16 v[236:237], v5 offset:38912
    ds_read_b64_tr_b16 v[238:239], v5 offset:39936
    buffer_load_dwordx4 a[160:163], v2, s[20:23], s50 offen offset:0 sc1
    v_mfma_f32_32x32x16_bf16 v[64:79], v[244:247], v[212:215], v[64:79]
    ds_read_b64_tr_b16 v[240:241], v6 offset:36864
    ds_read_b64_tr_b16 v[242:243], v6 offset:37888
    s_waitcnt lgkmcnt(6)
    v_mfma_f32_32x32x16_bf16 v[80:95], v[224:227], v[208:211], v[80:95]
    ds_read_b64_tr_b16 v[244:245], v6 offset:38912
    ds_read_b64_tr_b16 v[246:247], v6 offset:39936
    buffer_load_dwordx4 a[164:167], v2, s[20:23], s50 offen offset:1024 sc1
    v_mfma_f32_32x32x16_bf16 v[80:95], v[228:231], v[212:215], v[80:95]
    ds_read_b64_tr_b16 v[224:225], v5 offset:40960
    ds_read_b64_tr_b16 v[226:227], v5 offset:41984
    s_waitcnt vmcnt(14) lgkmcnt(6)
    v_mfma_f32_32x32x16_bf16 v[64:79], v[232:235], a[112:115], v[64:79]
    s_add_u32 m0, s42, 32768
    s_add_u32 s44, s32, 2228352
    ds_read_b64_tr_b16 v[228:229], v5 offset:43008
    ds_read_b64_tr_b16 v[230:231], v5 offset:44032
    buffer_load_dwordx4 v9, s[8:11], s44 offen lds
    v_mfma_f32_32x32x16_bf16 v[64:79], v[236:239], a[116:119], v[64:79]
    s_waitcnt vmcnt(8)
    v_cmp_gt_u32 s[60:61], 1, v15
    s_nop 3
    s_cmp_lg_u64 s[60:61], 0
    s_cbranch_scc1 L_slow4
L_back4:
    ds_read_b64_tr_b16 v[232:233], v6 offset:40960
    ds_read_b64_tr_b16 v[234:235], v6 offset:41984
    s_waitcnt lgkmcnt(6)
    v_mfma_f32_32x32x16_bf16 v[80:95], v[240:243], a[112:115], v[80:95]
    s_add_u32 s50, s35, 16777216
    ds_read_b64_tr_b16 v[236:237], v6 offset:43008
    ds_read_b64_tr_b16 v[238:239], v6 offset:44032
    buffer_load_dwordx4 a[168:171], v2, s[20:23], s50 offen offset:2048 sc1
    v_mfma_f32_32x32x16_bf16 v[80:95], v[244:247], a[116:119], v[80:95]
    ds_read_b64_tr_b16 v[240:241], v5 offset:45056
    ds_read_b64_tr_b16 v[242:243], v5 offset:46080
    s_waitcnt lgkmcnt(6)
    v_mfma_f32_32x32x16_bf16 v[64:79], v[224:227], a[120:123], v[64:79]
    ds_read_b64_tr_b16 v[244:245], v5 offset:47104
    ds_read_b64_tr_b16 v[246:247], v5 offset:48128
    buffer_load_dwordx4 a[172:175], v2, s[20:23], s50 offen offset:3072 sc1
    v_mfma_f32_32x32x16_bf16 v[64:79], v[228:231], a[124:127], v[64:79]
    ds_read_b64_tr_b16 v[224:225], v6 offset:45056
    ds_read_b64_tr_b16 v[226:227], v6 offset:46080
    s_waitcnt lgkmcnt(6)
    v_mfma_f32_32x32x16_bf16 v[80:95], v[232:235], a[120:123], v[80:95]
    s_add_u32 s50, s36, 16777216
    ds_read_b64_tr_b16 v[228:229], v6 offset:47104
    ds_read_b64_tr_b16 v[230:231], v6 offset:48128
    buffer_load_dwordx4 a[176:179], v2, s[20:23], s50 offen offset:2048 sc1
    v_mfma_f32_32x32x16_bf16 v[80:95], v[236:239], a[124:127], v[80:95]
    ds_read_b64_tr_b16 v[232:233], v5 offset:49152
    ds_read_b64_tr_b16 v[234:235], v5 offset:50176
    s_waitcnt lgkmcnt(6)
    v_mfma_f32_32x32x16_bf16 v[64:79], v[240:243], a[128:131], v[64:79]
    ds_read_b64_tr_b16 v[236:237], v5 offset:51200
    ds_read_b64_tr_b16 v[238:239], v5 offset:52224
    buffer_load_dwordx4 a[180:183], v2, s[20:23], s50 offen offset:3072 sc1
    v_mfma_f32_32x32x16_bf16 v[64:79], v[244:247], a[132:135], v[64:79]
    ds_read_b64_tr_b16 v[240:241], v6 offset:49152
    ds_read_b64_tr_b16 v[242:243], v6 offset:50176
    s_waitcnt lgkmcnt(6)
    v_mfma_f32_32x32x16_bf16 v[80:95], v[224:227], a[128:131], v[80:95]
    s_add_u32 s50, s37, 16777216
    ds_read_b64_tr_b16 v[244:245], v6 offset:51200
    ds_read_b64_tr_b16 v[246:247], v6 offset:52224
    buffer_load_dwordx4 a[184:187], v2, s[20:23], s50 offen offset:2048 sc1
    v_mfma_f32_32x32x16_bf16 v[80:95], v[228:231], a[132:135], v[80:95]
    ds_read_b64_tr_b16 v[224:225], v5 offset:53248
    ds_read_b64_tr_b16 v[226:227], v5 offset:54272
    s_waitcnt lgkmcnt(6)
    v_mfma_f32_32x32x16_bf16 v[64:79], v[232:235], a[136:139], v[64:79]
    ds_read_b64_tr_b16 v[228:229], v5 offset:55296
    ds_read_b64_tr_b16 v[230:231], v5 offset:56320
    buffer_load_dwordx4 a[188:191], v2, s[20:23], s50 offen offset:3072 sc1
    v_mfma_f32_32x32x16_bf16 v[64:79], v[236:239], a[140:143], v[64:79]
    s_barrier
    ds_read_b64_tr_b16 v[232:233], v6 offset:53248
    ds_read_b64_tr_b16 v[234:235], v6 offset:54272
    s_waitcnt lgkmcnt(6)
    v_mfma_f32_32x32x16_bf16 v[80:95], v[240:243], a[136:139], v[80:95]
    s_add_u32 s50, s38, 16777216
    ds_read_b64_tr_b16 v[236:237], v6 offset:55296
    ds_read_b64_tr_b16 v[238:239], v6 offset:56320
    buffer_load_dwordx4 a[192:195], v2, s[20:23], s50 offen offset:2048 sc1
    v_mfma_f32_32x32x16_bf16 v[80:95], v[244:247], a[140:143], v[80:95]
    ds_read_b64_tr_b16 v[240:241], v5 offset:57344
    ds_read_b64_tr_b16 v[242:243], v5 offset:58368
    s_waitcnt vmcnt(12) lgkmcnt(6)
    v_mfma_f32_32x32x16_bf16 v[64:79], v[224:227], a[144:147], v[64:79]
    ds_read_b64_tr_b16 v[244:245], v5 offset:59392
    ds_read_b64_tr_b16 v[246:247], v5 offset:60416
    buffer_load_dwordx4 a[196:199], v2, s[20:23], s50 offen offset:3072 sc1
    v_mfma_f32_32x32x16_bf16 v[64:79], v[228:231], a[148:151], v[64:79]
    ds_read_b64_tr_b16 v[224:225], v6 offset:57344
    ds_read_b64_tr_b16 v[226:227], v6 offset:58368
    s_waitcnt lgkmcnt(6)
    v_mfma_f32_32x32x16_bf16 v[80:95], v[232:235], a[144:147], v[80:95]
    ds_read_b64_tr_b16 v[228:229], v6 offset:59392
    ds_read_b64_tr_b16 v[230:231], v6 offset:60416
    buffer_load_dwordx4 v10, s[8:11], s44 offen offset:1024 lds
    v_mfma_f32_32x32x16_bf16 v[80:95], v[236:239], a[148:151], v[80:95]
    ds_read_b64_tr_b16 v[232:233], v5 offset:61440
    ds_read_b64_tr_b16 v[234:235], v5 offset:62464
    s_waitcnt vmcnt(12) lgkmcnt(6)
    v_mfma_f32_32x32x16_bf16 v[64:79], v[240:243], a[152:155], v[64:79]
    ds_read_b64_tr_b16 v[236:237], v5 offset:63488
    ds_read_b64_tr_b16 v[238:239], v5 offset:64512
    buffer_load_dwordx4 v11, s[8:11], s44 offen offset:2048 lds
    v_mfma_f32_32x32x16_bf16 v[64:79], v[244:247], a[156:159], v[64:79]
    ds_read_b64_tr_b16 v[240:241], v6 offset:61440
    ds_read_b64_tr_b16 v[242:243], v6 offset:62464
    s_waitcnt lgkmcnt(6)
    v_mfma_f32_32x32x16_bf16 v[80:95], v[224:227], a[152:155], v[80:95]
    ds_read_b64_tr_b16 v[244:245], v6 offset:63488
    ds_read_b64_tr_b16 v[246:247], v6 offset:64512
    buffer_load_dwordx4 v12, s[8:11], s44 offen offset:3072 lds
    v_mfma_f32_32x32x16_bf16 v[80:95], v[228:231], a[156:159], v[80:95]
    ds_read_b64_tr_b16 v[224:225], v7 offset:0
    ds_read_b64_tr_b16 v[226:227], v7 offset:1024
    s_waitcnt vmcnt(12) lgkmcnt(6)
    v_mfma_f32_32x32x16_bf16 v[64:79], v[232:235], a[160:163], v[64:79]
    s_add_u32 m0, s42, 36864
    s_add_u32 s44, s33, 2228352
    ds_read_b64_tr_b16 v[228:229], v7 offset:2048
    ds_read_b64_tr_b16 v[230:231], v7 offset:3072
    buffer_load_dwordx4 v9, s[8:11], s44 offen lds
    v_mfma_f32_32x32x16_bf16 v[64:79], v[236:239], a[164:167], v[64:79]
    ds_read_b64_tr_b16 v[232:233], v8 offset:0
    ds_read_b64_tr_b16 v[234:235], v8 offset:1024
    buffer_load_dwordx4 v10, s[8:11], s44 offen offset:1024 lds
    s_waitcnt lgkmcnt(6)
    v_mfma_f32_32x32x16_bf16 v[80:95], v[240:243], a[160:163], v[80:95]
    ds_read_b64_tr_b16 v[236:237], v8 offset:2048
    ds_read_b64_tr_b16 v[238:239], v8 offset:3072
    buffer_load_dwordx4 v11, s[8:11], s44 offen offset:2048 lds
    v_mfma_f32_32x32x16_bf16 v[80:95], v[244:247], a[164:167], v[80:95]
    ds_read_b64_tr_b16 v[240:241], v7 offset:4096
    ds_read_b64_tr_b16 v[242:243], v7 offset:5120
    buffer_load_dwordx4 v12, s[8:11], s44 offen offset:3072 lds
    s_waitcnt lgkmcnt(6)
    v_mfma_f32_32x32x16_bf16 v[64:79], v[224:227], v[216:219], v[64:79]
    s_add_u32 s50, s39, 16777216
    ds_read_b64_tr_b16 v[244:245], v7 offset:6144
    ds_read_b64_tr_b16 v[246:247], v7 offset:7168
    buffer_load_dwordx4 a[200:203], v2, s[20:23], s50 offen offset:2048 sc1
    v_mfma_f32_32x32x16_bf16 v[64:79], v[228:231], v[220:223], v[64:79]
    ds_read_b64_tr_b16 v[224:225], v8 offset:4096
    ds_read_b64_tr_b16 v[226:227], v8 offset:5120
    buffer_load_dwordx4 a[204:207], v2, s[20:23], s50 offen offset:3072 sc1
    s_waitcnt lgkmcnt(6)
    v_mfma_f32_32x32x16_bf16 v[80:95], v[232:235], v[216:219], v[80:95]
    s_add_u32 s50, s40, 16777216
    ds_read_b64_tr_b16 v[228:229], v8 offset:6144
    ds_read_b64_tr_b16 v[230:231], v8 offset:7168
    buffer_load_dwordx4 a[208:211], v2, s[20:23], s50 offen offset:2048 sc1
    v_mfma_f32_32x32x16_bf16 v[80:95], v[236:239], v[220:223], v[80:95]
    ds_read_b64_tr_b16 v[232:233], v7 offset:8192
    ds_read_b64_tr_b16 v[234:235], v7 offset:9216
    buffer_load_dwordx4 a[212:215], v2, s[20:23], s50 offen offset:3072 sc1
    s_waitcnt vmcnt(17) lgkmcnt(6)
    v_mfma_f32_32x32x16_bf16 v[64:79], v[240:243], a[168:171], v[64:79]
    s_add_u32 s50, s41, 16777216
    ds_read_b64_tr_b16 v[236:237], v7 offset:10240
    ds_read_b64_tr_b16 v[238:239], v7 offset:11264
    buffer_load_dwordx4 a[216:219], v2, s[20:23], s50 offen offset:2048 sc1
    v_mfma_f32_32x32x16_bf16 v[64:79], v[244:247], a[172:175], v[64:79]
    ds_read_b64_tr_b16 v[240:241], v8 offset:8192
    ds_read_b64_tr_b16 v[242:243], v8 offset:9216
    s_waitcnt lgkmcnt(6)
    v_mfma_f32_32x32x16_bf16 v[80:95], v[224:227], a[168:171], v[80:95]
    ds_read_b64_tr_b16 v[244:245], v8 offset:10240
    ds_read_b64_tr_b16 v[246:247], v8 offset:11264
    buffer_load_dwordx4 a[220:223], v2, s[20:23], s50 offen offset:3072 sc1
    v_mfma_f32_32x32x16_bf16 v[80:95], v[228:231], a[172:175], v[80:95]
    ds_read_b64_tr_b16 v[224:225], v7 offset:12288
    ds_read_b64_tr_b16 v[226:227], v7 offset:13312
    s_waitcnt vmcnt(17) lgkmcnt(6)
    v_mfma_f32_32x32x16_bf16 v[64:79], v[232:235], a[176:179], v[64:79]
    s_add_u32 m0, s42, 65536
    s_add_u32 s44, s32, 2293888
    ds_read_b64_tr_b16 v[228:229], v7 offset:14336
    ds_read_b64_tr_b16 v[230:231], v7 offset:15360
    buffer_load_dwordx4 v9, s[8:11], s44 offen lds
    v_mfma_f32_32x32x16_bf16 v[64:79], v[236:239], a[180:183], v[64:79]
    ds_read_b64_tr_b16 v[232:233], v8 offset:12288
    ds_read_b64_tr_b16 v[234:235], v8 offset:13312
    s_waitcnt lgkmcnt(6)
    v_mfma_f32_32x32x16_bf16 v[80:95], v[240:243], a[176:179], v[80:95]
    ds_read_b64_tr_b16 v[236:237], v8 offset:14336
    ds_read_b64_tr_b16 v[238:239], v8 offset:15360
    buffer_load_dwordx4 v10, s[8:11], s44 offen offset:1024 lds
    v_mfma_f32_32x32x16_bf16 v[80:95], v[244:247], a[180:183], v[80:95]
    buffer_load_dword v62, v51, s[8:11], s80 offen
    ds_read_b64_tr_b16 v[240:241], v7 offset:16384
    ds_read_b64_tr_b16 v[242:243], v7 offset:17408
    s_waitcnt vmcnt(18) lgkmcnt(6)
    v_mfma_f32_32x32x16_bf16 v[64:79], v[224:227], a[184:187], v[64:79]
    ds_read_b64_tr_b16 v[244:245], v7 offset:18432
    ds_read_b64_tr_b16 v[246:247], v7 offset:19456
    buffer_load_dwordx4 v11, s[8:11], s44 offen offset:2048 lds
    v_mfma_f32_32x32x16_bf16 v[64:79], v[228:231], a[188:191], v[64:79]
    ds_read_b64_tr_b16 v[224:225], v8 offset:16384
    ds_read_b64_tr_b16 v[226:227], v8 offset:17408
    s_waitcnt lgkmcnt(6)
    v_mfma_f32_32x32x16_bf16 v[80:95], v[232:235], a[184:187], v[80:95]
    ds_read_b64_tr_b16 v[228:229], v8 offset:18432
    ds_read_b64_tr_b16 v[230:231], v8 offset:19456
    buffer_load_dwordx4 v12, s[8:11], s44 offen offset:3072 lds
    v_mfma_f32_32x32x16_bf16 v[80:95], v[236:239], a[188:191], v[80:95]
    ds_read_b64_tr_b16 v[232:233], v7 offset:20480
    ds_read_b64_tr_b16 v[234:235], v7 offset:21504
    s_waitcnt vmcnt(18) lgkmcnt(6)
    v_mfma_f32_32x32x16_bf16 v[64:79], v[240:243], a[192:195], v[64:79]
    s_add_u32 m0, s42, 69632
    s_add_u32 s44, s33, 2293888
    ds_read_b64_tr_b16 v[236:237], v7 offset:22528
    ds_read_b64_tr_b16 v[238:239], v7 offset:23552
    buffer_load_dwordx4 v9, s[8:11], s44 offen lds
    v_mfma_f32_32x32x16_bf16 v[64:79], v[244:247], a[196:199], v[64:79]
    s_barrier
    ds_read_b64_tr_b16 v[240:241], v8 offset:20480
    ds_read_b64_tr_b16 v[242:243], v8 offset:21504
    s_waitcnt lgkmcnt(6)
    v_mfma_f32_32x32x16_bf16 v[80:95], v[224:227], a[192:195], v[80:95]
    ds_read_b64_tr_b16 v[244:245], v8 offset:22528
    ds_read_b64_tr_b16 v[246:247], v8 offset:23552
    buffer_load_dwordx4 v10, s[8:11], s44 offen offset:1024 lds
    v_mfma_f32_32x32x16_bf16 v[80:95], v[228:231], a[196:199], v[80:95]
    ds_read_b64_tr_b16 v[224:225], v7 offset:24576
    ds_read_b64_tr_b16 v[226:227], v7 offset:25600
    s_waitcnt vmcnt(11) lgkmcnt(6)
    v_mfma_f32_32x32x16_bf16 v[64:79], v[232:235], a[200:203], v[64:79]
    ds_read_b64_tr_b16 v[228:229], v7 offset:26624
    ds_read_b64_tr_b16 v[230:231], v7 offset:27648
    buffer_load_dwordx4 v11, s[8:11], s44 offen offset:2048 lds
    v_mfma_f32_32x32x16_bf16 v[64:79], v[236:239], a[204:207], v[64:79]
    ds_read_b64_tr_b16 v[232:233], v8 offset:24576
    ds_read_b64_tr_b16 v[234:235], v8 offset:25600
    s_waitcnt lgkmcnt(6)
    v_mfma_f32_32x32x16_bf16 v[80:95], v[240:243], a[200:203], v[80:95]
    ds_read_b64_tr_b16 v[236:237], v8 offset:26624
    ds_read_b64_tr_b16 v[238:239], v8 offset:27648
    buffer_load_dwordx4 v12, s[8:11], s44 offen offset:3072 lds
    v_mfma_f32_32x32x16_bf16 v[80:95], v[244:247], a[204:207], v[80:95]
    ds_read_b64_tr_b16 v[240:241], v7 offset:28672
    ds_read_b64_tr_b16 v[242:243], v7 offset:29696
    s_waitcnt vmcnt(11) lgkmcnt(6)
    v_mfma_f32_32x32x16_bf16 v[64:79], v[224:227], a[208:211], v[64:79]
    s_add_u32 m0, s42, 98304
    s_add_u32 s44, s32, 4194304
    ds_read_b64_tr_b16 v[244:245], v7 offset:30720
    ds_read_b64_tr_b16 v[246:247], v7 offset:31744
    buffer_load_dwordx4 v9, s[8:11], s44 offen lds
    v_mfma_f32_32x32x16_bf16 v[64:79], v[228:231], a[212:215], v[64:79]
    ds_read_b64_tr_b16 v[224:225], v8 offset:28672
    ds_read_b64_tr_b16 v[226:227], v8 offset:29696
    s_waitcnt lgkmcnt(6)
    v_mfma_f32_32x32x16_bf16 v[80:95], v[232:235], a[208:211], v[80:95]
    ds_read_b64_tr_b16 v[228:229], v8 offset:30720
    ds_read_b64_tr_b16 v[230:231], v8 offset:31744
    buffer_load_dwordx4 v10, s[8:11], s44 offen offset:1024 lds
    v_mfma_f32_32x32x16_bf16 v[80:95], v[236:239], a[212:215], v[80:95]
    ds_read_b64_tr_b16 v[232:233], v3 offset:0
    ds_read_b64_tr_b16 v[234:235], v3 offset:1024
    s_waitcnt vmcnt(11) lgkmcnt(6)
    v_mfma_f32_32x32x16_bf16 v[64:79], v[240:243], a[216:219], v[64:79]
    ds_read_b64_tr_b16 v[236:237], v3 offset:2048
    ds_read_b64_tr_b16 v[238:239], v3 offset:3072
    buffer_load_dwordx4 v11, s[8:11], s44 offen offset:2048 lds
    v_mfma_f32_32x32x16_bf16 v[64:79], v[244:247], a[220:223], v[64:79]
    ds_read_b64_tr_b16 v[240:241], v3 offset:4096
    ds_read_b64_tr_b16 v[242:243], v3 offset:5120
    s_waitcnt lgkmcnt(6)
    v_mfma_f32_32x32x16_bf16 v[80:95], v[224:227], a[216:219], v[80:95]
    ds_read_b64_tr_b16 v[244:245], v3 offset:6144
    ds_read_b64_tr_b16 v[246:247], v3 offset:7168
    buffer_load_dwordx4 v12, s[8:11], s44 offen offset:3072 lds
    v_mfma_f32_32x32x16_bf16 v[80:95], v[228:231], a[220:223], v[80:95]
    ds_read_b64_tr_b16 v[224:225], v3 offset:8192
    ds_read_b64_tr_b16 v[226:227], v3 offset:9216
    s_waitcnt lgkmcnt(6)
    v_mfma_f32_32x32x16_bf16 v[96:111], v[232:235], v[200:203], v[96:111]
    s_add_u32 m0, s42, 102400
    s_add_u32 s44, s33, 4194304
    ds_read_b64_tr_b16 v[228:229], v3 offset:10240
    ds_read_b64_tr_b16 v[230:231], v3 offset:11264
    buffer_load_dwordx4 v9, s[8:11], s44 offen lds
    v_mfma_f32_32x32x16_bf16 v[96:111], v[236:239], v[204:207], v[96:111]
    v_lshlrev_b32 v26, 16, v192
    v_and_b32 v27, s58, v192
    v_fma_f32 v26, v128, v64, v26
    ds_read_b64_tr_b16 v[232:233], v3 offset:12288
    ds_read_b64_tr_b16 v[234:235], v3 offset:13312
    s_waitcnt lgkmcnt(6)
    v_mfma_f32_32x32x16_bf16 v[96:111], v[240:243], a[56:59], v[96:111]
    v_fma_f32 v27, v129, v65, v27
    v_cvt_pk_bf16_f32 v192, v26, v27
    ds_read_b64_tr_b16 v[236:237], v3 offset:14336
    ds_read_b64_tr_b16 v[238:239], v3 offset:15360
    buffer_load_dwordx4 v10, s[8:11], s44 offen offset:1024 lds
    v_mfma_f32_32x32x16_bf16 v[96:111], v[244:247], a[60:63], v[96:111]
    v_lshlrev_b32 v28, 16, v193
    v_and_b32 v29, s58, v193
    v_fma_f32 v28, v130, v66, v28
    ds_read_b64_tr_b16 v[240:241], v3 offset:16384
    ds_read_b64_tr_b16 v[242:243], v3 offset:17408
    s_waitcnt lgkmcnt(6)
    v_mfma_f32_32x32x16_bf16 v[96:111], v[224:227], a[64:67], v[96:111]
    v_fma_f32 v29, v131, v67, v29
    v_cvt_pk_bf16_f32 v193, v28, v29
    ds_read_b64_tr_b16 v[244:245], v3 offset:18432
    ds_read_b64_tr_b16 v[246:247], v3 offset:19456
    buffer_load_dwordx4 v11, s[8:11], s44 offen offset:2048 lds
    v_mfma_f32_32x32x16_bf16 v[96:111], v[228:231], a[68:71], v[96:111]
    v_lshlrev_b32 v30, 16, v194
    v_and_b32 v31, s58, v194
    v_fma_f32 v30, v132, v68, v30
    ds_read_b64_tr_b16 v[224:225], v3 offset:20480
    ds_read_b64_tr_b16 v[226:227], v3 offset:21504
    s_waitcnt lgkmcnt(6)
    v_mfma_f32_32x32x16_bf16 v[96:111], v[232:235], a[72:75], v[96:111]
    v_fma_f32 v31, v133, v69, v31
    v_cvt_pk_bf16_f32 v194, v30, v31
    ds_read_b64_tr_b16 v[228:229], v3 offset:22528
    ds_read_b64_tr_b16 v[230:231], v3 offset:23552
    buffer_load_dwordx4 v12, s[8:11], s44 offen offset:3072 lds
    v_mfma_f32_32x32x16_bf16 v[96:111], v[236:239], a[76:79], v[96:111]
    v_lshlrev_b32 v32, 16, v195
    v_and_b32 v33, s58, v195
    v_fma_f32 v32, v134, v70, v32
    ds_read_b64_tr_b16 v[232:233], v3 offset:24576
    ds_read_b64_tr_b16 v[234:235], v3 offset:25600
    s_waitcnt lgkmcnt(6)
    v_mfma_f32_32x32x16_bf16 v[96:111], v[240:243], a[80:83], v[96:111]
    v_fma_f32 v33, v135, v71, v33
    v_cvt_pk_bf16_f32 v195, v32, v33
    ds_read_b64_tr_b16 v[236:237], v3 offset:26624
    ds_read_b64_tr_b16 v[238:239], v3 offset:27648
    v_mfma_f32_32x32x16_bf16 v[96:111], v[244:247], a[84:87], v[96:111]
    v_lshlrev_b32 v26, 16, v196
    v_and_b32 v27, s58, v196
    v_fma_f32 v26, v136, v72, v26
    ds_read_b64_tr_b16 v[240:241], v3 offset:28672
    ds_read_b64_tr_b16 v[242:243], v3 offset:29696
    s_waitcnt lgkmcnt(6)
    v_mfma_f32_32x32x16_bf16 v[96:111], v[224:227], a[88:91], v[96:111]
    v_fma_f32 v27, v137, v73, v27
    v_cvt_pk_bf16_f32 v196, v26, v27
    ds_read_b64_tr_b16 v[244:245], v3 offset:30720
    ds_read_b64_tr_b16 v[246:247], v3 offset:31744
    v_mfma_f32_32x32x16_bf16 v[96:111], v[228:231], a[92:95], v[96:111]
    v_lshlrev_b32 v28, 16, v197
    v_and_b32 v29, s58, v197
    v_fma_f32 v28, v138, v74, v28
    ds_read_b64_tr_b16 v[224:225], v4 offset:0
    ds_read_b64_tr_b16 v[226:227], v4 offset:1024
    s_waitcnt lgkmcnt(6)
    v_mfma_f32_32x32x16_bf16 v[96:111], v[232:235], a[96:99], v[96:111]
    v_fma_f32 v29, v139, v75, v29
    v_cvt_pk_bf16_f32 v197, v28, v29
    ds_read_b64_tr_b16 v[228:229], v4 offset:2048
    ds_read_b64_tr_b16 v[230:231], v4 offset:3072
    v_mfma_f32_32x32x16_bf16 v[96:111], v[236:239], a[100:103], v[96:111]
    v_lshlrev_b32 v30, 16, v198
    v_and_b32 v31, s58, v198
    v_fma_f32 v30, v140, v76, v30
    ds_read_b64_tr_b16 v[232:233], v4 offset:4096
    ds_read_b64_tr_b16 v[234:235], v4 offset:5120
    s_waitcnt lgkmcnt(6)
    v_mfma_f32_32x32x16_bf16 v[96:111], v[240:243], a[104:107], v[96:111]
    v_fma_f32 v31, v141, v77, v31
    v_cvt_pk_bf16_f32 v198, v30, v31
    ds_read_b64_tr_b16 v[236:237], v4 offset:6144
    ds_read_b64_tr_b16 v[238:239], v4 offset:7168
    v_mfma_f32_32x32x16_bf16 v[96:111], v[244:247], a[108:111], v[96:111]
    v_lshlrev_b32 v32, 16, v199
    v_and_b32 v33, s58, v199
    v_fma_f32 v32, v142, v78, v32
    ds_read_b64_tr_b16 v[240:241], v4 offset:8192
    ds_read_b64_tr_b16 v[242:243], v4 offset:9216
    s_waitcnt lgkmcnt(6)
    v_mfma_f32_32x32x16_bf16 v[112:127], v[224:227], v[200:203], v[112:127]
    v_fma_f32 v33, v143, v79, v33
    v_cvt_pk_bf16_f32 v199, v32, v33
    ds_read_b64_tr_b16 v[244:245], v4 offset:10240
    ds_read_b64_tr_b16 v[246:247], v4 offset:11264
    v_mfma_f32_32x32x16_bf16 v[112:127], v[228:231], v[204:207], v[112:127]
    s_barrier
    s_add_u32 s48, s34, 25165824
    s_cmp_lg_u32 s76, 0
    s_cbranch_scc0 L_ss1_0
    buffer_store_dwordx4 v[192:195], v1, s[20:23], s48 offen offset:0
    buffer_store_dwordx4 v[196:199], v1, s[20:23], s48 offen offset:1024
L_sj1_0:
    ds_read_b64_tr_b16 v[224:225], v4 offset:12288
    ds_read_b64_tr_b16 v[226:227], v4 offset:13312
    s_waitcnt lgkmcnt(6)
    v_mfma_f32_32x32x16_bf16 v[112:127], v[232:235], a[56:59], v[112:127]
    v_lshlrev_b32 v26, 16, v200
    v_and_b32 v27, s58, v200
    s_add_u32 m0, s42, 131072
    s_add_u32 s44, s32, 4194432
    ds_read_b64_tr_b16 v[228:229], v4 offset:14336
    ds_read_b64_tr_b16 v[230:231], v4 offset:15360
    buffer_load_dwordx4 v9, s[8:11], s44 offen lds
    v_mfma_f32_32x32x16_bf16 v[112:127], v[236:239], a[60:63], v[112:127]
    v_fma_f32 v26, v144, v80, v26
    v_fma_f32 v27, v145, v81, v27
    v_cvt_pk_bf16_f32 v200, v26, v27
    ds_read_b64_tr_b16 v[232:233], v4 offset:16384
    ds_read_b64_tr_b16 v[234:235], v4 offset:17408
    s_waitcnt lgkmcnt(6)
    v_mfma_f32_32x32x16_bf16 v[112:127], v[240:243], a[64:67], v[112:127]
    v_lshlrev_b32 v28, 16, v201
    v_and_b32 v29, s58, v201
    ds_read_b64_tr_b16 v[236:237], v4 offset:18432
    ds_read_b64_tr_b16 v[238:239], v4 offset:19456
    buffer_load_dwordx4 v10, s[8:11], s44 offen offset:1024 lds
    v_mfma_f32_32x32x16_bf16 v[112:127], v[244:247], a[68:71], v[112:127]
    v_fma_f32 v28, v146, v82, v28
    v_fma_f32 v29, v147, v83, v29
    v_cvt_pk_bf16_f32 v201, v28, v29
    ds_read_b64_tr_b16 v[240:241], v4 offset:20480
    ds_read_b64_tr_b16 v[242:243], v4 offset:21504
    s_waitcnt lgkmcnt(6)
    v_mfma_f32_32x32x16_bf16 v[112:127], v[224:227], a[72:75], v[112:127]
    v_lshlrev_b32 v30, 16, v202
    v_and_b32 v31, s58, v202
    ds_read_b64_tr_b16 v[244:245], v4 offset:22528
    ds_read_b64_tr_b16 v[246:247], v4 offset:23552
    buffer_load_dwordx4 v11, s[8:11], s44 offen offset:2048 lds
    v_mfma_f32_32x32x16_bf16 v[112:127], v[228:231], a[76:79], v[112:127]
    v_fma_f32 v30, v148, v84, v30
    v_fma_f32 v31, v149, v85, v31
    v_cvt_pk_bf16_f32 v202, v30, v31
    ds_read_b64_tr_b16 v[224:225], v4 offset:24576
    ds_read_b64_tr_b16 v[226:227], v4 offset:25600
    s_waitcnt lgkmcnt(6)
    v_mfma_f32_32x32x16_bf16 v[112:127], v[232:235], a[80:83], v[112:127]
    v_lshlrev_b32 v32, 16, v203
    v_and_b32 v33, s58, v203
    ds_read_b64_tr_b16 v[228:229], v4 offset:26624
    ds_read_b64_tr_b16 v[230:231], v4 offset:27648
    buffer_load_dwordx4 v12, s[8:11], s44 offen offset:3072 lds
    v_mfma_f32_32x32x16_bf16 v[112:127], v[236:239], a[84:87], v[112:127]
    v_fma_f32 v32, v150, v86, v32
    v_fma_f32 v33, v151, v87, v33
    v_cvt_pk_bf16_f32 v203, v32, v33
    ds_read_b64_tr_b16 v[232:233], v4 offset:28672
    ds_read_b64_tr_b16 v[234:235], v4 offset:29696
    s_waitcnt lgkmcnt(6)
    v_mfma_f32_32x32x16_bf16 v[112:127], v[240:243], a[88:91], v[112:127]
    v_lshlrev_b32 v26, 16, v204
    v_and_b32 v27, s58, v204
    s_add_u32 m0, s42, 135168
    s_add_u32 s44, s33, 4194432
    ds_read_b64_tr_b16 v[236:237], v4 offset:30720
    ds_read_b64_tr_b16 v[238:239], v4 offset:31744
    buffer_load_dwordx4 v9, s[8:11], s44 offen lds
    v_mfma_f32_32x32x16_bf16 v[112:127], v[244:247], a[92:95], v[112:127]
    v_fma_f32 v26, v152, v88, v26
    v_fma_f32 v27, v153, v89, v27
    v_cvt_pk_bf16_f32 v204, v26, v27
    ds_read_b64_tr_b16 v[240:241], v3 offset:32768
    ds_read_b64_tr_b16 v[242:243], v3 offset:33792
    s_waitcnt lgkmcnt(6)
    v_mfma_f32_32x32x16_bf16 v[112:127], v[224:227], a[96:99], v[112:127]
    v_lshlrev_b32 v28, 16, v205
    v_and_b32 v29, s58, v205
    ds_read_b64_tr_b16 v[244:245], v3 offset:34816
    ds_read_b64_tr_b16 v[246:247], v3 offset:35840
    buffer_load_dwordx4 v10, s[8:11], s44 offen offset:1024 lds
    v_mfma_f32_32x32x16_bf16 v[112:127], v[228:231], a[100:103], v[112:127]
    v_fma_f32 v28, v154, v90, v28
    v_fma_f32 v29, v155, v91, v29
    v_cvt_pk_bf16_f32 v205, v28, v29
    ds_read_b64_tr_b16 v[224:225], v3 offset:36864
    ds_read_b64_tr_b16 v[226:227], v3 offset:37888
    s_waitcnt lgkmcnt(6)
    v_mfma_f32_32x32x16_bf16 v[112:127], v[232:235], a[104:107], v[112:127]
    v_lshlrev_b32 v30, 16, v206
    v_and_b32 v31, s58, v206
    ds_read_b64_tr_b16 v[228:229], v3 offset:38912
    ds_read_b64_tr_b16 v[230:231], v3 offset:39936
    buffer_load_dwordx4 v11, s[8:11], s44 offen offset:2048 lds
    v_mfma_f32_32x32x16_bf16 v[112:127], v[236:239], a[108:111], v[112:127]
    v_fma_f32 v30, v156, v92, v30
    v_fma_f32 v31, v157, v93, v31
    v_cvt_pk_bf16_f32 v206, v30, v31
    ds_read_b64_tr_b16 v[232:233], v3 offset:40960
    ds_read_b64_tr_b16 v[234:235], v3 offset:41984
    s_waitcnt lgkmcnt(6)
    v_mfma_f32_32x32x16_bf16 v[96:111], v[240:243], v[208:211], v[96:111]
    v_lshlrev_b32 v32, 16, v207
    v_and_b32 v33, s58, v207
    ds_read_b64_tr_b16 v[236:237], v3 offset:43008
    ds_read_b64_tr_b16 v[238:239], v3 offset:44032
    buffer_load_dwordx4 v12, s[8:11], s44 offen offset:3072 lds
    v_mfma_f32_32x32x16_bf16 v[96:111], v[244:247], v[212:215], v[96:111]
    s_waitcnt vmcnt(8)
    v_mov_b32 v47, 2
    s_cmp_lg_u32 s76, 0
    s_cbranch_scc0 L_fs1_0
    buffer_store_dword v47, v13, s[20:23], 0 offen offset:0
L_fj1_0:
    ds_read_b64_tr_b16 v[240:241], v3 offset:45056
    ds_read_b64_tr_b16 v[242:243], v3 offset:46080
    s_waitcnt lgkmcnt(6)
    v_mfma_f32_32x32x16_bf16 v[96:111], v[224:227], a[112:115], v[96:111]
    v_fma_f32 v32, v158, v94, v32
    v_fma_f32 v33, v159, v95, v33
    ds_read_b64_tr_b16 v[244:245], v3 offset:47104
    ds_read_b64_tr_b16 v[246:247], v3 offset:48128
    v_mfma_f32_32x32x16_bf16 v[96:111], v[228:231], a[116:119], v[96:111]
    v_cvt_pk_bf16_f32 v207, v32, v33
    ds_read_b64_tr_b16 v[224:225], v3 offset:49152
    ds_read_b64_tr_b16 v[226:227], v3 offset:50176
    s_waitcnt lgkmcnt(6)
    v_mfma_f32_32x32x16_bf16 v[96:111], v[232:235], a[120:123], v[96:111]
    s_cmp_lg_u32 s76, 0
    s_cbranch_scc0 L_ss1_1
    buffer_store_dwordx4 v[200:203], v1, s[20:23], s48 offen offset:2048
    buffer_store_dwordx4 v[204:207], v1, s[20:23], s48 offen offset:3072
L_sj1_1:
    ds_read_b64_tr_b16 v[228:229], v3 offset:51200
    ds_read_b64_tr_b16 v[230:231], v3 offset:52224
    v_mfma_f32_32x32x16_bf16 v[96:111], v[236:239], a[124:127], v[96:111]
    ds_read_b64_tr_b16 v[232:233], v3 offset:53248
    ds_read_b64_tr_b16 v[234:235], v3 offset:54272
    s_waitcnt lgkmcnt(6)
    v_mfma_f32_32x32x16_bf16 v[96:111], v[240:243], a[128:131], v[96:111]
    ds_read_b64_tr_b16 v[236:237], v3 offset:55296
    ds_read_b64_tr_b16 v[238:239], v3 offset:56320
    v_mfma_f32_32x32x16_bf16 v[96:111], v[244:247], a[132:135], v[96:111]
    ds_read_b64_tr_b16 v[240:241], v3 offset:57344
    ds_read_b64_tr_b16 v[242:243], v3 offset:58368
    s_waitcnt lgkmcnt(6)
    v_mfma_f32_32x32x16_bf16 v[96:111], v[224:227], a[136:139], v[96:111]
    ds_read_b64_tr_b16 v[244:245], v3 offset:59392
    ds_read_b64_tr_b16 v[246:247], v3 offset:60416
    v_mfma_f32_32x32x16_bf16 v[96:111], v[228:231], a[140:143], v[96:111]
    ds_read_b64_tr_b16 v[224:225], v3 offset:61440
    ds_read_b64_tr_b16 v[226:227], v3 offset:62464
    s_waitcnt lgkmcnt(6)
    v_mfma_f32_32x32x16_bf16 v[96:111], v[232:235], a[144:147], v[96:111]
    ds_read_b64_tr_b16 v[228:229], v3 offset:63488
    ds_read_b64_tr_b16 v[230:231], v3 offset:64512
    v_mfma_f32_32x32x16_bf16 v[96:111], v[236:239], a[148:151], v[96:111]
    ds_read_b64_tr_b16 v[232:233], v4 offset:32768
    ds_read_b64_tr_b16 v[234:235], v4 offset:33792
    s_waitcnt lgkmcnt(6)
    v_mfma_f32_32x32x16_bf16 v[96:111], v[240:243], a[152:155], v[96:111]
    ds_read_b64_tr_b16 v[236:237], v4 offset:34816
    ds_read_b64_tr_b16 v[238:239], v4 offset:35840
    v_mfma_f32_32x32x16_bf16 v[96:111], v[244:247], a[156:159], v[96:111]
    ds_read_b64_tr_b16 v[240:241], v4 offset:36864
    ds_read_b64_tr_b16 v[242:243], v4 offset:37888
    s_waitcnt lgkmcnt(6)
    v_mfma_f32_32x32x16_bf16 v[96:111], v[224:227], a[160:163], v[96:111]
    ds_read_b64_tr_b16 v[244:245], v4 offset:38912
    ds_read_b64_tr_b16 v[246:247], v4 offset:39936
    v_mfma_f32_32x32x16_bf16 v[96:111], v[228:231], a[164:167], v[96:111]
    buffer_load_ushort v16, v24, s[12:15], s47 offen offset:0
    ds_read_b64_tr_b16 v[224:225], v4 offset:40960
    ds_read_b64_tr_b16 v[226:227], v4 offset:41984
    s_waitcnt lgkmcnt(6)
    v_mfma_f32_32x32x16_bf16 v[112:127], v[232:235], v[208:211], v[112:127]
    ds_read_b64_tr_b16 v[228:229], v4 offset:43008
    ds_read_b64_tr_b16 v[230:231], v4 offset:44032
    v_mfma_f32_32x32x16_bf16 v[112:127], v[236:239], v[212:215], v[112:127]
    buffer_load_ushort v20, v24, s[12:15], s47 offen offset:64
    s_barrier
    ds_read_b64_tr_b16 v[232:233], v4 offset:45056
    ds_read_b64_tr_b16 v[234:235], v4 offset:46080
    s_waitcnt lgkmcnt(6)
    v_mfma_f32_32x32x16_bf16 v[112:127], v[240:243], a[112:115], v[112:127]
    s_add_u32 m0, s42, 0
    s_add_u32 s44, s32, 4259840
    ds_read_b64_tr_b16 v[236:237], v4 offset:47104
    ds_read_b64_tr_b16 v[238:239], v4 offset:48128
    buffer_load_dwordx4 v9, s[8:11], s44 offen lds
    v_mfma_f32_32x32x16_bf16 v[112:127], v[244:247], a[116:119], v[112:127]
    ds_read_b64_tr_b16 v[240:241], v4 offset:49152
    ds_read_b64_tr_b16 v[242:243], v4 offset:50176
    s_waitcnt lgkmcnt(6)
    v_mfma_f32_32x32x16_bf16 v[112:127], v[224:227], a[120:123], v[112:127]
    s_waitcnt vmcnt(3)
    v_mov_b32 v47, 2
    s_cmp_lg_u32 s76, 0
    s_cbranch_scc0 L_fs1_1
    buffer_store_dword v47, v13, s[20:23], 0 offen offset:32
L_fj1_1:
    ds_read_b64_tr_b16 v[244:245], v4 offset:51200
    ds_read_b64_tr_b16 v[246:247], v4 offset:52224
    buffer_load_dwordx4 v10, s[8:11], s44 offen offset:1024 lds
    v_mfma_f32_32x32x16_bf16 v[112:127], v[228:231], a[124:127], v[112:127]
    buffer_load_dword v15, v14, s[20:23], 0 offen offset:0 sc1
    ds_read_b64_tr_b16 v[224:225], v4 offset:53248
    ds_read_b64_tr_b16 v[226:227], v4 offset:54272
    s_waitcnt lgkmcnt(6)
    v_mfma_f32_32x32x16_bf16 v[112:127], v[232:235], a[128:131], v[112:127]
    ds_read_b64_tr_b16 v[228:229], v4 offset:55296
    ds_read_b64_tr_b16 v[230:231], v4 offset:56320
    buffer_load_dwordx4 v11, s[8:11], s44 offen offset:2048 lds
    v_mfma_f32_32x32x16_bf16 v[112:127], v[236:239], a[132:135], v[112:127]
    ds_read_b64_tr_b16 v[232:233], v4 offset:57344
    ds_read_b64_tr_b16 v[234:235], v4 offset:58368
    s_waitcnt lgkmcnt(6)
    v_mfma_f32_32x32x16_bf16 v[112:127], v[240:243], a[136:139], v[112:127]
    ds_read_b64_tr_b16 v[236:237], v4 offset:59392
    ds_read_b64_tr_b16 v[238:239], v4 offset:60416
    buffer_load_dwordx4 v12, s[8:11], s44 offen offset:3072 lds
    v_mfma_f32_32x32x16_bf16 v[112:127], v[244:247], a[140:143], v[112:127]
    ds_read_b64_tr_b16 v[240:241], v4 offset:61440
    ds_read_b64_tr_b16 v[242:243], v4 offset:62464
    s_waitcnt lgkmcnt(6)
    v_mfma_f32_32x32x16_bf16 v[112:127], v[224:227], a[144:147], v[112:127]
    s_add_u32 m0, s42, 4096
    s_add_u32 s44, s33, 4259840
    ds_read_b64_tr_b16 v[244:245], v4 offset:63488
    ds_read_b64_tr_b16 v[246:247], v4 offset:64512
    buffer_load_dwordx4 v9, s[8:11], s44 offen lds
    v_mfma_f32_32x32x16_bf16 v[112:127], v[228:231], a[148:151], v[112:127]
    ds_read_b64_tr_b16 v[224:225], v5 offset:0
    ds_read_b64_tr_b16 v[226:227], v5 offset:1024
    s_waitcnt lgkmcnt(6)
    v_mfma_f32_32x32x16_bf16 v[112:127], v[232:235], a[152:155], v[112:127]
    ds_read_b64_tr_b16 v[228:229], v5 offset:2048
    ds_read_b64_tr_b16 v[230:231], v5 offset:3072
    buffer_load_dwordx4 v10, s[8:11], s44 offen offset:1024 lds
    v_mfma_f32_32x32x16_bf16 v[112:127], v[236:239], a[156:159], v[112:127]
    ds_read_b64_tr_b16 v[232:233], v5 offset:4096
    ds_read_b64_tr_b16 v[234:235], v5 offset:5120
    s_waitcnt lgkmcnt(6)
    v_mfma_f32_32x32x16_bf16 v[112:127], v[240:243], a[160:163], v[112:127]
    ds_read_b64_tr_b16 v[236:237], v5 offset:6144
    ds_read_b64_tr_b16 v[238:239], v5 offset:7168
    buffer_load_dwordx4 v11, s[8:11], s44 offen offset:2048 lds
    v_mfma_f32_32x32x16_bf16 v[112:127], v[244:247], a[164:167], v[112:127]
    ds_read_b64_tr_b16 v[240:241], v5 offset:8192
    ds_read_b64_tr_b16 v[242:243], v5 offset:9216
    s_waitcnt lgkmcnt(6)
    v_mfma_f32_32x32x16_bf16 v[96:111], v[224:227], v[216:219], v[96:111]
    ds_read_b64_tr_b16 v[244:245], v5 offset:10240
    ds_read_b64_tr_b16 v[246:247], v5 offset:11264
    buffer_load_dwordx4 v12, s[8:11], s44 offen offset:3072 lds
    v_mfma_f32_32x32x16_bf16 v[96:111], v[228:231], v[220:223], v[96:111]
    ds_read_b64_tr_b16 v[224:225], v5 offset:12288
    ds_read_b64_tr_b16 v[226:227], v5 offset:13312
    s_waitcnt lgkmcnt(6)
    v_mfma_f32_32x32x16_bf16 v[96:111], v[232:235], a[168:171], v[96:111]
    ds_read_b64_tr_b16 v[228:229], v5 offset:14336
    ds_read_b64_tr_b16 v[230:231], v5 offset:15360
    v_mfma_f32_32x32x16_bf16 v[96:111], v[236:239], a[172:175], v[96:111]
    ds_read_b64_tr_b16 v[232:233], v5 offset:16384
    ds_read_b64_tr_b16 v[234:235], v5 offset:17408
    s_waitcnt lgkmcnt(6)
    v_mfma_f32_32x32x16_bf16 v[96:111], v[240:243], a[176:179], v[96:111]
    ds_read_b64_tr_b16 v[236:237], v5 offset:18432
    ds_read_b64_tr_b16 v[238:239], v5 offset:19456
    v_mfma_f32_32x32x16_bf16 v[96:111], v[244:247], a[180:183], v[96:111]
    s_waitcnt vmcnt(6)
    v_cmp_gt_u32 s[60:61], 2, v15
    s_nop 3
    s_cmp_lg_u64 s[60:61], 0
    s_cbranch_scc1 L_slow5
L_back5:
    ds_read_b64_tr_b16 v[240:241], v5 offset:20480
    ds_read_b64_tr_b16 v[242:243], v5 offset:21504
    s_waitcnt lgkmcnt(6)
    v_mfma_f32_32x32x16_bf16 v[96:111], v[224:227], a[184:187], v[96:111]
    s_add_u32 s50, s35, 25165824
    ds_read_b64_tr_b16 v[244:245], v5 offset:22528
    ds_read_b64_tr_b16 v[246:247], v5 offset:23552
    buffer_load_dwordx4 a[0:3], v1, s[20:23], s50 offen offset:0 sc1
    v_mfma_f32_32x32x16_bf16 v[96:111], v[228:231], a[188:191], v[96:111]
    ds_read_b64_tr_b16 v[224:225], v5 offset:24576
    ds_read_b64_tr_b16 v[226:227], v5 offset:25600
    s_waitcnt lgkmcnt(6)
    v_mfma_f32_32x32x16_bf16 v[96:111], v[232:235], a[192:195], v[96:111]
    ds_read_b64_tr_b16 v[228:229], v5 offset:26624
    ds_read_b64_tr_b16 v[230:231], v5 offset:27648
    buffer_load_dwordx4 a[4:7], v1, s[20:23], s50 offen offset:1024 sc1
    v_mfma_f32_32x32x16_bf16 v[96:111], v[236:239], a[196:199], v[96:111]
    ds_read_b64_tr_b16 v[232:233], v5 offset:28672
    ds_read_b64_tr_b16 v[234:235], v5 offset:29696
    s_waitcnt lgkmcnt(6)
    v_mfma_f32_32x32x16_bf16 v[96:111], v[240:243], a[200:203], v[96:111]
    s_add_u32 s50, s36, 25165824
    ds_read_b64_tr_b16 v[236:237], v5 offset:30720
    ds_read_b64_tr_b16 v[238:239], v5 offset:31744
    buffer_load_dwordx4 a[8:11], v1, s[20:23], s50 offen offset:0 sc1
    v_mfma_f32_32x32x16_bf16 v[96:111], v[244:247], a[204:207], v[96:111]
    ds_read_b64_tr_b16 v[240:241], v6 offset:0
    ds_read_b64_tr_b16 v[242:243], v6 offset:1024
    s_waitcnt lgkmcnt(6)
    v_mfma_f32_32x32x16_bf16 v[96:111], v[224:227], a[208:211], v[96:111]
    ds_read_b64_tr_b16 v[244:245], v6 offset:2048
    ds_read_b64_tr_b16 v[246:247], v6 offset:3072
    buffer_load_dwordx4 a[12:15], v1, s[20:23], s50 offen offset:1024 sc1
    v_mfma_f32_32x32x16_bf16 v[96:111], v[228:231], a[212:215], v[96:111]
    ds_read_b64_tr_b16 v[224:225], v6 offset:4096
    ds_read_b64_tr_b16 v[226:227], v6 offset:5120
    s_waitcnt lgkmcnt(6)
    v_mfma_f32_32x32x16_bf16 v[96:111], v[232:235], a[216:219], v[96:111]
    s_add_u32 s50, s37, 25165824
    ds_read_b64_tr_b16 v[228:229], v6 offset:6144
    ds_read_b64_tr_b16 v[230:231], v6 offset:7168
    buffer_load_dwordx4 a[16:19], v1, s[20:23], s50 offen offset:0 sc1
    v_mfma_f32_32x32x16_bf16 v[96:111], v[236:239], a[220:223], v[96:111]
    ds_read_b64_tr_b16 v[232:233], v6 offset:8192
    ds_read_b64_tr_b16 v[234:235], v6 offset:9216
    s_waitcnt lgkmcnt(6)
    v_mfma_f32_32x32x16_bf16 v[112:127], v[240:243], v[216:219], v[112:127]
    ds_read_b64_tr_b16 v[236:237], v6 offset:10240
    ds_read_b64_tr_b16 v[238:239], v6 offset:11264
    buffer_load_dwordx4 a[20:23], v1, s[20:23], s50 offen offset:1024 sc1
    v_mfma_f32_32x32x16_bf16 v[112:127], v[244:247], v[220:223], v[112:127]
    s_barrier
    ds_read_b64_tr_b16 v[240:241], v6 offset:12288
    ds_read_b64_tr_b16 v[242:243], v6 offset:13312
    s_waitcnt lgkmcnt(6)
    v_mfma_f32_32x32x16_bf16 v[112:127], v[224:227], a[168:171], v[112:127]
    s_add_u32 s50, s38, 25165824
    ds_read_b64_tr_b16 v[244:245], v6 offset:14336
    ds_read_b64_tr_b16 v[246:247], v6 offset:15360
    buffer_load_dwordx4 a[24:27], v1, s[20:23], s50 offen offset:0 sc1
    v_mfma_f32_32x32x16_bf16 v[112:127], v[228:231], a[172:175], v[112:127]
    v_lshlrev_b32 v26, 16, v208
    v_and_b32 v27, s58, v208
    v_fma_f32 v26, v160, v96, v26
    ds_read_b64_tr_b16 v[224:225], v6 offset:16384
    ds_read_b64_tr_b16 v[226:227], v6 offset:17408
    s_waitcnt lgkmcnt(6)
    v_mfma_f32_32x32x16_bf16 v[112:127], v[232:235], a[176:179], v[112:127]
    v_fma_f32 v27, v161, v97, v27
    v_cvt_pk_bf16_f32 v208, v26, v27
    ds_read_b64_tr_b16 v[228:229], v6 offset:18432
    ds_read_b64_tr_b16 v[230:231], v6 offset:19456
    buffer_load_dwordx4 a[28:31], v1, s[20:23], s50 offen offset:1024 sc1
    v_mfma_f32_32x32x16_bf16 v[112:127], v[236:239], a[180:183], v[112:127]
    v_lshlrev_b32 v28, 16, v209
    v_and_b32 v29, s58, v209
    v_fma_f32 v28, v162, v98, v28
    ds_read_b64_tr_b16 v[232:233], v6 offset:20480
    ds_read_b64_tr_b16 v[234:235], v6 offset:21504
    s_waitcnt lgkmcnt(6)
    v_mfma_f32_32x32x16_bf16 v[112:127], v[240:243], a[184:187], v[112:127]
    v_fma_f32 v29, v163, v99, v29
    v_cvt_pk_bf16_f32 v209, v28, v29
    s_add_u32 s50, s39, 25165824
    ds_read_b64_tr_b16 v[236:237], v6 offset:22528
    ds_read_b64_tr_b16 v[238:239], v6 offset:23552
    buffer_load_dwordx4 a[32:35], v1, s[20:23], s50 offen offset:0 sc1
    v_mfma_f32_32x32x16_bf16 v[112:127], v[244:247], a[188:191], v[112:127]
    v_lshlrev_b32 v30, 16, v210
    v_and_b32 v31, s58, v210
    v_fma_f32 v30, v164, v100, v30
    ds_read_b64_tr_b16 v[240:241], v6 offset:24576
    ds_read_b64_tr_b16 v[242:243], v6 offset:25600
    s_waitcnt lgkmcnt(6)
    v_mfma_f32_32x32x16_bf16 v[112:127], v[224:227], a[192:195], v[112:127]
    v_fma_f32 v31, v165, v101, v31
    v_cvt_pk_bf16_f32 v210, v30, v31
    ds_read_b64_tr_b16 v[244:245], v6 offset:26624
    ds_read_b64_tr_b16 v[246:247], v6 offset:27648
    buffer_load_dwordx4 a[36:39], v1, s[20:23], s50 offen offset:1024 sc1
    v_mfma_f32_32x32x16_bf16 v[112:127], v[228:231], a[196:199], v[112:127]
    v_lshlrev_b32 v32, 16, v211
    v_and_b32 v33, s58, v211
    v_fma_f32 v32, v166, v102, v32
    ds_read_b64_tr_b16 v[224:225], v6 offset:28672
    ds_read_b64_tr_b16 v[226:227], v6 offset:29696
    s_waitcnt lgkmcnt(6)
    v_mfma_f32_32x32x16_bf16 v[112:127], v[232:235], a[200:203], v[112:127]
    v_fma_f32 v33, v167, v103, v33
    v_cvt_pk_bf16_f32 v211, v32, v33
    s_add_u32 s50, s40, 25165824
    ds_read_b64_tr_b16 v[228:229], v6 offset:30720
    ds_read_b64_tr_b16 v[230:231], v6 offset:31744
    buffer_load_dwordx4 a[40:43], v1, s[20:23], s50 offen offset:0 sc1
    v_mfma_f32_32x32x16_bf16 v[112:127], v[236:239], a[204:207], v[112:127]
    v_lshlrev_b32 v26, 16, v212
    v_and_b32 v27, s58, v212
    v_fma_f32 v26, v168, v104, v26
    ds_read_b64_tr_b16 v[232:233], v5 offset:32768
    ds_read_b64_tr_b16 v[234:235], v5 offset:33792
    s_waitcnt lgkmcnt(6)
    v_mfma_f32_32x32x16_bf16 v[112:127], v[240:243], a[208:211], v[112:127]
    v_fma_f32 v27, v169, v105, v27
    v_cvt_pk_bf16_f32 v212, v26, v27
    ds_read_b64_tr_b16 v[236:237], v5 offset:34816
    ds_read_b64_tr_b16 v[238:239], v5 offset:35840
    buffer_load_dwordx4 a[44:47], v1, s[20:23], s50 offen offset:1024 sc1
    v_mfma_f32_32x32x16_bf16 v[112:127], v[244:247], a[212:215], v[112:127]
    v_lshlrev_b32 v28, 16, v213
    v_and_b32 v29, s58, v213
    v_fma_f32 v28, v170, v106, v28
    ds_read_b64_tr_b16 v[240:241], v6 offset:32768
    ds_read_b64_tr_b16 v[242:243], v6 offset:33792
    s_waitcnt lgkmcnt(6)
    v_mfma_f32_32x32x16_bf16 v[112:127], v[224:227], a[216:219], v[112:127]
    v_fma_f32 v29, v171, v107, v29
    v_cvt_pk_bf16_f32 v213, v28, v29
    s_add_u32 s50, s41, 25165824
    ds_read_b64_tr_b16 v[244:245], v6 offset:34816
    ds_read_b64_tr_b16 v[246:247], v6 offset:35840
    buffer_load_dwordx4 a[48:51], v1, s[20:23], s50 offen offset:0 sc1
    v_mfma_f32_32x32x16_bf16 v[112:127], v[228:231], a[220:223], v[112:127]
    v_mfma_f32_32x32x16_bf16 v[64:79], v[16:19], v[56:59], 0
    ds_read_b64_tr_b16 v[224:225], v5 offset:36864
    ds_read_b64_tr_b16 v[226:227], v5 offset:37888
    s_waitcnt lgkmcnt(6)
    v_mfma_f32_32x32x16_bf16 v[64:79], v[232:235], v[192:195], v[64:79]
    v_lshlrev_b32 v30, 16, v214
    v_and_b32 v31, s58, v214
    ds_read_b64_tr_b16 v[228:229], v5 offset:38912
    ds_read_b64_tr_b16 v[230:231], v5 offset:39936
    buffer_load_dwordx4 a[52:55], v1, s[20:23], s50 offen offset:1024 sc1
    v_mfma_f32_32x32x16_bf16 v[64:79], v[236:239], v[196:199], v[64:79]
    v_mfma_f32_32x32x16_bf16 v[80:95], v[20:23], v[56:59], 0
    buffer_load_ushort v16, v24, s[12:15], s47 offen offset:128
    ds_read_b64_tr_b16 v[232:233], v6 offset:36864
    ds_read_b64_tr_b16 v[234:235], v6 offset:37888
    s_waitcnt lgkmcnt(6)
    v_mfma_f32_32x32x16_bf16 v[80:95], v[240:243], v[192:195], v[80:95]
    v_fma_f32 v30, v172, v108, v30
    v_fma_f32 v31, v173, v109, v31
    s_add_u32 m0, s42, 32768
    s_add_u32 s44, s32, 4259968
    ds_read_b64_tr_b16 v[236:237], v6 offset:38912
    ds_read_b64_tr_b16 v[238:239], v6 offset:39936
    buffer_load_dwordx4 v9, s[8:11], s44 offen lds
    v_mfma_f32_32x32x16_bf16 v[80:95], v[244:247], v[196:199], v[80:95]
    buffer_load_ushort v20, v24, s[12:15], s47 offen offset:192
    v_cvt_pk_bf16_f32 v214, v30, v31
    v_lshlrev_b32 v32, 16, v215
    ds_read_b64_tr_b16 v[240:241], v5 offset:40960
    ds_read_b64_tr_b16 v[242:243], v5 offset:41984
    s_waitcnt vmcnt(15) lgkmcnt(6)
    v_mfma_f32_32x32x16_bf16 v[64:79], v[224:227], a[0:3], v[64:79]
    v_and_b32 v33, s58, v215
    v_fma_f32 v32, v174, v110, v32
    ds_read_b64_tr_b16 v[244:245], v5 offset:43008
    ds_read_b64_tr_b16 v[246:247], v5 offset:44032
    buffer_load_dwordx4 v10, s[8:11], s44 offen offset:1024 lds
    v_mfma_f32_32x32x16_bf16 v[64:79], v[228:231], a[4:7], v[64:79]
    v_fma_f32 v33, v175, v111, v33
    v_cvt_pk_bf16_f32 v215, v32, v33
    ds_read_b64_tr_b16 v[224:225], v6 offset:40960
    ds_read_b64_tr_b16 v[226:227], v6 offset:41984
    s_waitcnt lgkmcnt(6)
    v_mfma_f32_32x32x16_bf16 v[80:95], v[232:235], a[0:3], v[80:95]
    s_cmp_lg_u32 s76, 0
    s_cbranch_scc0 L_ss1_2
    buffer_store_dwordx4 v[208:211], v2, s[20:23], s48 offen offset:0
    buffer_store_dwordx4 v[212:215], v2, s[20:23], s48 offen offset:1024
L_sj1_2:
    ds_read_b64_tr_b16 v[228:229], v6 offset:43008
    ds_read_b64_tr_b16 v[230:231], v6 offset:44032
    buffer_load_dwordx4 v11, s[8:11], s44 offen offset:2048 lds
    v_mfma_f32_32x32x16_bf16 v[80:95], v[236:239], a[4:7], v[80:95]
    v_lshlrev_b32 v26, 16, v216
    v_and_b32 v27, s58, v216
    v_fma_f32 v26, v176, v112, v26
    ds_read_b64_tr_b16 v[232:233], v5 offset:45056
    ds_read_b64_tr_b16 v[234:235], v5 offset:46080
    s_waitcnt vmcnt(17) lgkmcnt(6)
    v_mfma_f32_32x32x16_bf16 v[64:79], v[240:243], a[8:11], v[64:79]
    v_fma_f32 v27, v177, v113, v27
    v_cvt_pk_bf16_f32 v216, v26, v27
    ds_read_b64_tr_b16 v[236:237], v5 offset:47104
    ds_read_b64_tr_b16 v[238:239], v5 offset:48128
    buffer_load_dwordx4 v12, s[8:11], s44 offen offset:3072 lds
    v_mfma_f32_32x32x16_bf16 v[64:79], v[244:247], a[12:15], v[64:79]
    v_lshlrev_b32 v28, 16, v217
    v_and_b32 v29, s58, v217
    v_fma_f32 v28, v178, v114, v28
    ds_read_b64_tr_b16 v[240:241], v6 offset:45056
    ds_read_b64_tr_b16 v[242:243], v6 offset:46080
    s_waitcnt lgkmcnt(6)
    v_mfma_f32_32x32x16_bf16 v[80:95], v[224:227], a[8:11], v[80:95]
    v_fma_f32 v29, v179, v115, v29
    v_cvt_pk_bf16_f32 v217, v28, v29
    s_add_u32 m0, s42, 36864
    s_add_u32 s44, s33, 4259968
    ds_read_b64_tr_b16 v[244:245], v6 offset:47104
    ds_read_b64_tr_b16 v[246:247], v6 offset:48128
    buffer_load_dwordx4 v9, s[8:11], s44 offen lds
    v_mfma_f32_32x32x16_bf16 v[80:95], v[228:231], a[12:15], v[80:95]
    v_lshlrev_b32 v30, 16, v218
    v_and_b32 v31, s58, v218
    v_fma_f32 v30, v180, v116, v30
    ds_read_b64_tr_b16 v[224:225], v5 offset:49152
    ds_read_b64_tr_b16 v[226:227], v5 offset:50176
    s_waitcnt vmcnt(17) lgkmcnt(6)
    v_mfma_f32_32x32x16_bf16 v[64:79], v[232:235], a[16:19], v[64:79]
    v_fma_f32 v31, v181, v117, v31
    v_cvt_pk_bf16_f32 v218, v30, v31
    ds_read_b64_tr_b16 v[228:229], v5 offset:51200
    ds_read_b64_tr_b16 v[230:231], v5 offset:52224
    buffer_load_dwordx4 v10, s[8:11], s44 offen offset:1024 lds
    v_mfma_f32_32x32x16_bf16 v[64:79], v[236:239], a[20:23], v[64:79]
    v_lshlrev_b32 v32, 16, v219
    v_and_b32 v33, s58, v219
    v_fma_f32 v32, v182, v118, v32
    ds_read_b64_tr_b16 v[232:233], v6 offset:49152
    ds_read_b64_tr_b16 v[234:235], v6 offset:50176
    s_waitcnt lgkmcnt(6)
    v_mfma_f32_32x32x16_bf16 v[80:95], v[240:243], a[16:19], v[80:95]
    v_fma_f32 v33, v183, v119, v33
    v_cvt_pk_bf16_f32 v219, v32, v33
    ds_read_b64_tr_b16 v[236:237], v6 offset:51200
    ds_read_b64_tr_b16 v[238:239], v6 offset:52224
    buffer_load_dwordx4 v11, s[8:11], s44 offen offset:2048 lds
    v_mfma_f32_32x32x16_bf16 v[80:95], v[244:247], a[20:23], v[80:95]
    v_lshlrev_b32 v26, 16, v220
    v_and_b32 v27, s58, v220
    v_fma_f32 v26, v184, v120, v26
    ds_read_b64_tr_b16 v[240:241], v5 offset:53248
    ds_read_b64_tr_b16 v[242:243], v5 offset:54272
    s_waitcnt vmcnt(17) lgkmcnt(6)
    v_mfma_f32_32x32x16_bf16 v[64:79], v[224:227], a[24:27], v[64:79]
    v_fma_f32 v27, v185, v121, v27
    v_cvt_pk_bf16_f32 v220, v26, v27
    ds_read_b64_tr_b16 v[244:245], v5 offset:55296
    ds_read_b64_tr_b16 v[246:247], v5 offset:56320
    buffer_load_dwordx4 v12, s[8:11], s44 offen offset:3072 lds
    v_mfma_f32_32x32x16_bf16 v[64:79], v[228:231], a[28:31], v[64:79]
    s_barrier
    v_lshlrev_b32 v28, 16, v221
    ds_read_b64_tr_b16 v[224:225], v6 offset:53248
    ds_read_b64_tr_b16 v[226:227], v6 offset:54272
    s_waitcnt lgkmcnt(6)
    v_mfma_f32_32x32x16_bf16 v[80:95], v[232:235], a[24:27], v[80:95]
    v_and_b32 v29, s58, v221
    v_fma_f32 v28, v186, v122, v28
    s_add_u32 m0, s42, 65536
    s_add_u32 s44, s32, 4325376
    ds_read_b64_tr_b16 v[228:229], v6 offset:55296
    ds_read_b64_tr_b16 v[230:231], v6 offset:56320
    buffer_load_dwordx4 v9, s[8:11], s44 offen lds
    v_mfma_f32_32x32x16_bf16 v[80:95], v[236:239], a[28:31], v[80:95]
    v_fma_f32 v29, v187, v123, v29
    v_cvt_pk_bf16_f32 v221, v28, v29
    v_lshlrev_b32 v30, 16, v222
    ds_read_b64_tr_b16 v[232:233], v5 offset:57344
    ds_read_b64_tr_b16 v[234:235], v5 offset:58368
    s_waitcnt vmcnt(17) lgkmcnt(6)
    v_mfma_f32_32x32x16_bf16 v[64:79], v[240:243], a[32:35], v[64:79]
    v_and_b32 v31, s58, v222
    v_fma_f32 v30, v188, v124, v30
    ds_read_b64_tr_b16 v[236:237], v5 offset:59392
    ds_read_b64_tr_b16 v[238:239], v5 offset:60416
    buffer_load_dwordx4 v10, s[8:11], s44 offen offset:1024 lds
    v_mfma_f32_32x32x16_bf16 v[64:79], v[244:247], a[36:39], v[64:79]
    v_fma_f32 v31, v189, v125, v31
    v_cvt_pk_bf16_f32 v222, v30, v31
    v_lshlrev_b32 v32, 16, v223
    buffer_load_dword v15, v14, s[20:23], 0 offen offset:32 sc1
    ds_read_b64_tr_b16 v[240:241], v6 offset:57344
    ds_read_b64_tr_b16 v[242:243], v6 offset:58368
    s_waitcnt lgkmcnt(6)
    v_mfma_f32_32x32x16_bf16 v[80:95], v[224:227], a[32:35], v[80:95]
    s_waitcnt vmcnt(9)
    v_mov_b32 v47, 2
    s_cmp_lg_u32 s76, 0
    s_cbranch_scc0 L_fs1_2
    buffer_store_dword v47, v13, s[20:23], 0 offen offset:64
L_fj1_2:
    ds_read_b64_tr_b16 v[244:245], v6 offset:59392
    ds_read_b64_tr_b16 v[246:247], v6 offset:60416
    buffer_load_dwordx4 v11, s[8:11], s44 offen offset:2048 lds
    v_mfma_f32_32x32x16_bf16 v[80:95], v[228:231], a[36:39], v[80:95]
    v_and_b32 v33, s58, v223
    v_fma_f32 v32, v190, v126, v32
    v_fma_f32 v33, v191, v127, v33
    ds_read_b64_tr_b16 v[224:225], v5 offset:61440
    ds_read_b64_tr_b16 v[226:227], v5 offset:62464
    s_waitcnt lgkmcnt(6)
    v_mfma_f32_32x32x16_bf16 v[64:79], v[232:235], a[40:43], v[64:79]
    v_cvt_pk_bf16_f32 v223, v32, v33
    ds_read_b64_tr_b16 v[228:229], v5 offset:63488
    ds_read_b64_tr_b16 v[230:231], v5 offset:64512
    buffer_load_dwordx4 v12, s[8:11], s44 offen offset:3072 lds
    v_mfma_f32_32x32x16_bf16 v[64:79], v[236:239], a[44:47], v[64:79]
    s_cmp_lg_u32 s76, 0
    s_cbranch_scc0 L_ss1_3
    buffer_store_dwordx4 v[216:219], v2, s[20:23], s48 offen offset:2048
    buffer_store_dwordx4 v[220:223], v2, s[20:23], s48 offen offset:3072
L_sj1_3:
    ds_read_b64_tr_b16 v[232:233], v6 offset:61440
    ds_read_b64_tr_b16 v[234:235], v6 offset:62464
    s_waitcnt lgkmcnt(6)
    v_mfma_f32_32x32x16_bf16 v[80:95], v[240:243], a[40:43], v[80:95]
    s_add_u32 m0, s42, 69632
    s_add_u32 s44, s33, 4325376
    ds_read_b64_tr_b16 v[236:237], v6 offset:63488
    ds_read_b64_tr_b16 v[238:239], v6 offset:64512
    buffer_load_dwordx4 v9, s[8:11], s44 offen lds
    v_mfma_f32_32x32x16_bf16 v[80:95], v[244:247], a[44:47], v[80:95]
    ds_read_b64_tr_b16 v[240:241], v7 offset:0
    ds_read_b64_tr_b16 v[242:243], v7 offset:1024
    s_waitcnt lgkmcnt(6)
    v_mfma_f32_32x32x16_bf16 v[64:79], v[224:227], a[48:51], v[64:79]
    ds_read_b64_tr_b16 v[244:245], v7 offset:2048
    ds_read_b64_tr_b16 v[246:247], v7 offset:3072
    buffer_load_dwordx4 v10, s[8:11], s44 offen offset:1024 lds
    v_mfma_f32_32x32x16_bf16 v[64:79], v[228:231], a[52:55], v[64:79]
    ds_read_b64_tr_b16 v[224:225], v7 offset:4096
    ds_read_b64_tr_b16 v[226:227], v7 offset:5120
    s_waitcnt lgkmcnt(6)
    v_mfma_f32_32x32x16_bf16 v[80:95], v[232:235], a[48:51], v[80:95]
    ds_read_b64_tr_b16 v[228:229], v7 offset:6144
    ds_read_b64_tr_b16 v[230:231], v7 offset:7168
    buffer_load_dwordx4 v11, s[8:11], s44 offen offset:2048 lds
    v_mfma_f32_32x32x16_bf16 v[80:95], v[236:239], a[52:55], v[80:95]
    v_mfma_f32_32x32x16_bf16 v[96:111], v[16:19], v[56:59], 0
    ds_read_b64_tr_b16 v[232:233], v7 offset:8192
    ds_read_b64_tr_b16 v[234:235], v7 offset:9216
    s_waitcnt lgkmcnt(6)
    v_mfma_f32_32x32x16_bf16 v[96:111], v[240:243], v[192:195], v[96:111]
    ds_read_b64_tr_b16 v[236:237], v7 offset:10240
    ds_read_b64_tr_b16 v[238:239], v7 offset:11264
    buffer_load_dwordx4 v12, s[8:11], s44 offen offset:3072 lds
    v_mfma_f32_32x32x16_bf16 v[96:111], v[244:247], v[196:199], v[96:111]
    ds_read_b64_tr_b16 v[240:241], v7 offset:12288
    ds_read_b64_tr_b16 v[242:243], v7 offset:13312
    s_waitcnt lgkmcnt(6)
    v_mfma_f32_32x32x16_bf16 v[96:111], v[224:227], a[0:3], v[96:111]
    ds_read_b64_tr_b16 v[244:245], v7 offset:14336
    ds_read_b64_tr_b16 v[246:247], v7 offset:15360
    v_mfma_f32_32x32x16_bf16 v[96:111], v[228:231], a[4:7], v[96:111]
    ds_read_b64_tr_b16 v[224:225], v7 offset:16384
    ds_read_b64_tr_b16 v[226:227], v7 offset:17408
    s_waitcnt lgkmcnt(6)
    v_mfma_f32_32x32x16_bf16 v[96:111], v[232:235], a[8:11], v[96:111]
    ds_read_b64_tr_b16 v[228:229], v7 offset:18432
    ds_read_b64_tr_b16 v[230:231], v7 offset:19456
    v_mfma_f32_32x32x16_bf16 v[96:111], v[236:239], a[12:15], v[96:111]
    s_waitcnt vmcnt(9)
    v_cmp_gt_u32 s[60:61], 2, v15
    s_nop 3
    s_cmp_lg_u64 s[60:61], 0
    s_cbranch_scc1 L_slow6
L_back6:
    ds_read_b64_tr_b16 v[232:233], v7 offset:20480
    ds_read_b64_tr_b16 v[234:235], v7 offset:21504
    s_waitcnt lgkmcnt(6)
    v_mfma_f32_32x32x16_bf16 v[96:111], v[240:243], a[16:19], v[96:111]
    s_add_u32 s50, s35, 25165824
    ds_read_b64_tr_b16 v[236:237], v7 offset:22528
    ds_read_b64_tr_b16 v[238:239], v7 offset:23552
    buffer_load_dwordx4 a[56:59], v1, s[20:23], s50 offen offset:2048 sc1
    v_mfma_f32_32x32x16_bf16 v[96:111], v[244:247], a[20:23], v[96:111]
    ds_read_b64_tr_b16 v[240:241], v7 offset:24576
    ds_read_b64_tr_b16 v[242:243], v7 offset:25600
    s_waitcnt lgkmcnt(6)
    v_mfma_f32_32x32x16_bf16 v[96:111], v[224:227], a[24:27], v[96:111]
    ds_read_b64_tr_b16 v[244:245], v7 offset:26624
    ds_read_b64_tr_b16 v[246:247], v7 offset:27648
    buffer_load_dwordx4 a[60:63], v1, s[20:23], s50 offen offset:3072 sc1
    v_mfma_f32_32x32x16_bf16 v[96:111], v[228:231], a[28:31], v[96:111]
    s_waitcnt vmcnt(6)
    v_mov_b32 v47, 2
    s_cmp_lg_u32 s76, 0
    s_cbranch_scc0 L_fs1_3
    buffer_store_dword v47, v13, s[20:23], 0 offen offset:96
L_fj1_3:
    ds_read_b64_tr_b16 v[224:225], v7 offset:28672
    ds_read_b64_tr_b16 v[226:227], v7 offset:29696
    s_waitcnt lgkmcnt(6)
    v_mfma_f32_32x32x16_bf16 v[96:111], v[232:235], a[32:35], v[96:111]
    s_add_u32 s50, s36, 25165824
    ds_read_b64_tr_b16 v[228:229], v7 offset:30720
    ds_read_b64_tr_b16 v[230:231], v7 offset:31744
    buffer_load_dwordx4 a[64:67], v1, s[20:23], s50 offen offset:2048 sc1
    v_mfma_f32_32x32x16_bf16 v[96:111], v[236:239], a[36:39], v[96:111]
    ds_read_b64_tr_b16 v[232:233], v8 offset:0
    ds_read_b64_tr_b16 v[234:235], v8 offset:1024
    s_waitcnt lgkmcnt(6)
    v_mfma_f32_32x32x16_bf16 v[96:111], v[240:243], a[40:43], v[96:111]
    ds_read_b64_tr_b16 v[236:237], v8 offset:2048
    ds_read_b64_tr_b16 v[238:239], v8 offset:3072
    buffer_load_dwordx4 a[68:71], v1, s[20:23], s50 offen offset:3072 sc1
    v_mfma_f32_32x32x16_bf16 v[96:111], v[244:247], a[44:47], v[96:111]
    ds_read_b64_tr_b16 v[240:241], v8 offset:4096
    ds_read_b64_tr_b16 v[242:243], v8 offset:5120
    s_waitcnt lgkmcnt(6)
    v_mfma_f32_32x32x16_bf16 v[96:111], v[224:227], a[48:51], v[96:111]
    s_add_u32 s50, s37, 25165824
    ds_read_b64_tr_b16 v[244:245], v8 offset:6144
    ds_read_b64_tr_b16 v[246:247], v8 offset:7168
    buffer_load_dwordx4 a[72:75], v1, s[20:23], s50 offen offset:2048 sc1
    v_mfma_f32_32x32x16_bf16 v[96:111], v[228:231], a[52:55], v[96:111]
    v_mfma_f32_32x32x16_bf16 v[112:127], v[20:23], v[56:59], 0
    ds_read_b64_tr_b16 v[224:225], v8 offset:8192
    ds_read_b64_tr_b16 v[226:227], v8 offset:9216
    s_waitcnt lgkmcnt(6)
    v_mfma_f32_32x32x16_bf16 v[112:127], v[232:235], v[192:195], v[112:127]
    ds_read_b64_tr_b16 v[228:229], v8 offset:10240
    ds_read_b64_tr_b16 v[230:231], v8 offset:11264
    buffer_load_dwordx4 a[76:79], v1, s[20:23], s50 offen offset:3072 sc1
    v_mfma_f32_32x32x16_bf16 v[112:127], v[236:239], v[196:199], v[112:127]
    s_barrier
    ds_read_b64_tr_b16 v[232:233], v8 offset:12288
    ds_read_b64_tr_b16 v[234:235], v8 offset:13312
    s_waitcnt lgkmcnt(6)
    v_mfma_f32_32x32x16_bf16 v[112:127], v[240:243], a[0:3], v[112:127]
    s_add_u32 s50, s38, 25165824
    ds_read_b64_tr_b16 v[236:237], v8 offset:14336
    ds_read_b64_tr_b16 v[238:239], v8 offset:15360
    buffer_load_dwordx4 a[80:83], v1, s[20:23], s50 offen offset:2048 sc1
    v_mfma_f32_32x32x16_bf16 v[112:127], v[244:247], a[4:7], v[112:127]
    ds_read_b64_tr_b16 v[240:241], v8 offset:16384
    ds_read_b64_tr_b16 v[242:243], v8 offset:17408
    s_waitcnt lgkmcnt(6)
    v_mfma_f32_32x32x16_bf16 v[112:127], v[224:227], a[8:11], v[112:127]
    ds_read_b64_tr_b16 v[244:245], v8 offset:18432
    ds_read_b64_tr_b16 v[246:247], v8 offset:19456
    buffer_load_dwordx4 a[84:87], v1, s[20:23], s50 offen offset:3072 sc1
    v_mfma_f32_32x32x16_bf16 v[112:127], v[228:231], a[12:15], v[112:127]
    ds_read_b64_tr_b16 v[224:225], v8 offset:20480
    ds_read_b64_tr_b16 v[226:227], v8 offset:21504
    s_waitcnt lgkmcnt(6)
    v_mfma_f32_32x32x16_bf16 v[112:127], v[232:235], a[16:19], v[112:127]
    s_add_u32 s50, s39, 25165824
    ds_read_b64_tr_b16 v[228:229], v8 offset:22528
    ds_read_b64_tr_b16 v[230:231], v8 offset:23552
    buffer_load_dwordx4 a[88:91], v1, s[20:23], s50 offen offset:2048 sc1
    v_mfma_f32_32x32x16_bf16 v[112:127], v[236:239], a[20:23], v[112:127]
    ds_read_b64_tr_b16 v[232:233], v8 offset:24576
    ds_read_b64_tr_b16 v[234:235], v8 offset:25600
    s_waitcnt lgkmcnt(6)
    v_mfma_f32_32x32x16_bf16 v[112:127], v[240:243], a[24:27], v[112:127]
    ds_read_b64_tr_b16 v[236:237], v8 offset:26624
    ds_read_b64_tr_b16 v[238:239], v8 offset:27648
    buffer_load_dwordx4 a[92:95], v1, s[20:23], s50 offen offset:3072 sc1
    v_mfma_f32_32x32x16_bf16 v[112:127], v[244:247], a[28:31], v[112:127]
    ds_read_b64_tr_b16 v[240:241], v8 offset:28672
    ds_read_b64_tr_b16 v[242:243], v8 offset:29696
    s_waitcnt lgkmcnt(6)
    v_mfma_f32_32x32x16_bf16 v[112:127], v[224:227], a[32:35], v[112:127]
    s_add_u32 s50, s40, 25165824
    ds_read_b64_tr_b16 v[244:245], v8 offset:30720
    ds_read_b64_tr_b16 v[246:247], v8 offset:31744
    buffer_load_dwordx4 a[96:99], v1, s[20:23], s50 offen offset:2048 sc1
    v_mfma_f32_32x32x16_bf16 v[112:127], v[228:231], a[36:39], v[112:127]
    ds_read_b64_tr_b16 v[224:225], v3 offset:0
    ds_read_b64_tr_b16 v[226:227], v3 offset:1024
    s_waitcnt lgkmcnt(6)
    v_mfma_f32_32x32x16_bf16 v[112:127], v[232:235], a[40:43], v[112:127]
    ds_read_b64_tr_b16 v[228:229], v3 offset:2048
    ds_read_b64_tr_b16 v[230:231], v3 offset:3072
    buffer_load_dwordx4 a[100:103], v1, s[20:23], s50 offen offset:3072 sc1
    v_mfma_f32_32x32x16_bf16 v[112:127], v[236:239], a[44:47], v[112:127]
    ds_read_b64_tr_b16 v[232:233], v4 offset:0
    ds_read_b64_tr_b16 v[234:235], v4 offset:1024
    s_waitcnt lgkmcnt(6)
    v_mfma_f32_32x32x16_bf16 v[112:127], v[240:243], a[48:51], v[112:127]
    s_add_u32 s50, s41, 25165824
    ds_read_b64_tr_b16 v[236:237], v4 offset:2048
    ds_read_b64_tr_b16 v[238:239], v4 offset:3072
    buffer_load_dwordx4 a[104:107], v1, s[20:23], s50 offen offset:2048 sc1
    v_mfma_f32_32x32x16_bf16 v[112:127], v[244:247], a[52:55], v[112:127]
    ds_read_b64_tr_b16 v[240:241], v3 offset:4096
    ds_read_b64_tr_b16 v[242:243], v3 offset:5120
    s_waitcnt lgkmcnt(6)
    v_mfma_f32_32x32x16_bf16 v[64:79], v[224:227], v[200:203], v[64:79]
    ds_read_b64_tr_b16 v[244:245], v3 offset:6144
    ds_read_b64_tr_b16 v[246:247], v3 offset:7168
    buffer_load_dwordx4 a[108:111], v1, s[20:23], s50 offen offset:3072 sc1
    v_mfma_f32_32x32x16_bf16 v[64:79], v[228:231], v[204:207], v[64:79]
    ds_read_b64_tr_b16 v[224:225], v4 offset:4096
    ds_read_b64_tr_b16 v[226:227], v4 offset:5120
    s_waitcnt lgkmcnt(6)
    v_mfma_f32_32x32x16_bf16 v[80:95], v[232:235], v[200:203], v[80:95]
    s_add_u32 m0, s42, 98304
    s_add_u32 s44, s32, 4325504
    ds_read_b64_tr_b16 v[228:229], v4 offset:6144
    ds_read_b64_tr_b16 v[230:231], v4 offset:7168
    buffer_load_dwordx4 v9, s[8:11], s44 offen lds
    v_mfma_f32_32x32x16_bf16 v[80:95], v[236:239], v[204:207], v[80:95]
    ds_read_b64_tr_b16 v[232:233], v3 offset:8192
    ds_read_b64_tr_b16 v[234:235], v3 offset:9216
    s_waitcnt vmcnt(14) lgkmcnt(6)
    v_mfma_f32_32x32x16_bf16 v[64:79], v[240:243], a[56:59], v[64:79]
    ds_read_b64_tr_b16 v[236:237], v3 offset:10240
    ds_read_b64_tr_b16 v[238:239], v3 offset:11264
    buffer_load_dwordx4 v10, s[8:11], s44 offen offset:1024 lds
    v_mfma_f32_32x32x16_bf16 v[64:79], v[244:247], a[60:63], v[64:79]
    ds_read_b64_tr_b16 v[240:241], v4 offset:8192
    ds_read_b64_tr_b16 v[242:243], v4 offset:9216
    s_waitcnt lgkmcnt(6)
    v_mfma_f32_32x32x16_bf16 v[80:95], v[224:227], a[56:59], v[80:95]
    ds_read_b64_tr_b16 v[244:245], v4 offset:10240
    ds_read_b64_tr_b16 v[246:247], v4 offset:11264
    buffer_load_dwordx4 v11, s[8:11], s44 offen offset:2048 lds
    v_mfma_f32_32x32x16_bf16 v[80:95], v[228:231], a[60:63], v[80:95]
    ds_read_b64_tr_b16 v[224:225], v3 offset:12288
    ds_read_b64_tr_b16 v[226:227], v3 offset:13312
    s_waitcnt vmcnt(13) lgkmcnt(6)
    v_mfma_f32_32x32x16_bf16 v[64:79], v[232:235], a[64:67], v[64:79]
    ds_read_b64_tr_b16 v[228:229], v3 offset:14336
    ds_read_b64_tr_b16 v[230:231], v3 offset:15360
    buffer_load_dwordx4 v12, s[8:11], s44 offen offset:3072 lds
    v_mfma_f32_32x32x16_bf16 v[64:79], v[236:239], a[68:71], v[64:79]
    ds_read_b64_tr_b16 v[232:233], v4 offset:12288
    ds_read_b64_tr_b16 v[234:235], v4 offset:13312
    s_waitcnt lgkmcnt(6)
    v_mfma_f32_32x32x16_bf16 v[80:95], v[240:243], a[64:67], v[80:95]
    s_add_u32 m0, s42, 102400
    s_add_u32 s44, s33, 4325504
    ds_read_b64_tr_b16 v[236:237], v4 offset:14336
    ds_read_b64_tr_b16 v[238:239], v4 offset:15360
    buffer_load_dwordx4 v9, s[8:11], s44 offen lds
    v_mfma_f32_32x32x16_bf16 v[80:95], v[244:247], a[68:71], v[80:95]
    ds_read_b64_tr_b16 v[240:241], v3 offset:16384
    ds_read_b64_tr_b16 v[242:243], v3 offset:17408
    s_waitcnt vmcnt(13) lgkmcnt(6)
    v_mfma_f32_32x32x16_bf16 v[64:79], v[224:227], a[72:75], v[64:79]
    ds_read_b64_tr_b16 v[244:245], v3 offset:18432
    ds_read_b64_tr_b16 v[246:247], v3 offset:19456
    buffer_load_dwordx4 v10, s[8:11], s44 offen offset:1024 lds
    v_mfma_f32_32x32x16_bf16 v[64:79], v[228:231], a[76:79], v[64:79]
    ds_read_b64_tr_b16 v[224:225], v4 offset:16384
    ds_read_b64_tr_b16 v[226:227], v4 offset:17408
    s_waitcnt lgkmcnt(6)
    v_mfma_f32_32x32x16_bf16 v[80:95], v[232:235], a[72:75], v[80:95]
    ds_read_b64_tr_b16 v[228:229], v4 offset:18432
    ds_read_b64_tr_b16 v[230:231], v4 offset:19456
    buffer_load_dwordx4 v11, s[8:11], s44 offen offset:2048 lds
    v_mfma_f32_32x32x16_bf16 v[80:95], v[236:239], a[76:79], v[80:95]
    ds_read_b64_tr_b16 v[232:233], v3 offset:20480
    ds_read_b64_tr_b16 v[234:235], v3 offset:21504
    s_waitcnt vmcnt(13) lgkmcnt(6)
    v_mfma_f32_32x32x16_bf16 v[64:79], v[240:243], a[80:83], v[64:79]
    ds_read_b64_tr_b16 v[236:237], v3 offset:22528
    ds_read_b64_tr_b16 v[238:239], v3 offset:23552
    buffer_load_dwordx4 v12, s[8:11], s44 offen offset:3072 lds
    v_mfma_f32_32x32x16_bf16 v[64:79], v[244:247], a[84:87], v[64:79]
    s_barrier
    ds_read_b64_tr_b16 v[240:241], v4 offset:20480
    ds_read_b64_tr_b16 v[242:243], v4 offset:21504
    s_waitcnt lgkmcnt(6)
    v_mfma_f32_32x32x16_bf16 v[80:95], v[224:227], a[80:83], v[80:95]
    s_add_u32 m0, s42, 131072
    s_add_u32 s44, s32, 4390912
    ds_read_b64_tr_b16 v[244:245], v4 offset:22528
    ds_read_b64_tr_b16 v[246:247], v4 offset:23552
    buffer_load_dwordx4 v9, s[8:11], s44 offen lds
    v_mfma_f32_32x32x16_bf16 v[80:95], v[228:231], a[84:87], v[80:95]
    ds_read_b64_tr_b16 v[224:225], v3 offset:24576
    ds_read_b64_tr_b16 v[226:227], v3 offset:25600
    s_waitcnt vmcnt(13) lgkmcnt(6)
    v_mfma_f32_32x32x16_bf16 v[64:79], v[232:235], a[88:91], v[64:79]
    ds_read_b64_tr_b16 v[228:229], v3 offset:26624
    ds_read_b64_tr_b16 v[230:231], v3 offset:27648
    buffer_load_dwordx4 v10, s[8:11], s44 offen offset:1024 lds
    v_mfma_f32_32x32x16_bf16 v[64:79], v[236:239], a[92:95], v[64:79]
    buffer_load_dword v15, v14, s[20:23], 0 offen offset:64 sc1
    ds_read_b64_tr_b16 v[232:233], v4 offset:24576
    ds_read_b64_tr_b16 v[234:235], v4 offset:25600
    s_waitcnt lgkmcnt(6)
    v_mfma_f32_32x32x16_bf16 v[80:95], v[240:243], a[88:91], v[80:95]
    ds_read_b64_tr_b16 v[236:237], v4 offset:26624
    ds_read_b64_tr_b16 v[238:239], v4 offset:27648
    buffer_load_dwordx4 v11, s[8:11], s44 offen offset:2048 lds
    v_mfma_f32_32x32x16_bf16 v[80:95], v[244:247], a[92:95], v[80:95]
    ds_read_b64_tr_b16 v[240:241], v3 offset:28672
    ds_read_b64_tr_b16 v[242:243], v3 offset:29696
    s_waitcnt vmcnt(14) lgkmcnt(6)
    v_mfma_f32_32x32x16_bf16 v[64:79], v[224:227], a[96:99], v[64:79]
    ds_read_b64_tr_b16 v[244:245], v3 offset:30720
    ds_read_b64_tr_b16 v[246:247], v3 offset:31744
    buffer_load_dwordx4 v12, s[8:11], s44 offen offset:3072 lds
    v_mfma_f32_32x32x16_bf16 v[64:79], v[228:231], a[100:103], v[64:79]
    ds_read_b64_tr_b16 v[224:225], v4 offset:28672
    ds_read_b64_tr_b16 v[226:227], v4 offset:29696
    s_waitcnt lgkmcnt(6)
    v_mfma_f32_32x32x16_bf16 v[80:95], v[232:235], a[96:99], v[80:95]
    s_add_u32 m0, s42, 135168
    s_add_u32 s44, s33, 4390912
    ds_read_b64_tr_b16 v[228:229], v4 offset:30720
    ds_read_b64_tr_b16 v[230:231], v4 offset:31744
    buffer_load_dwordx4 v9, s[8:11], s44 offen lds
    v_mfma_f32_32x32x16_bf16 v[80:95], v[236:239], a[100:103], v[80:95]
    ds_read_b64_tr_b16 v[232:233], v3 offset:32768
    ds_read_b64_tr_b16 v[234:235], v3 offset:33792
    s_waitcnt vmcnt(14) lgkmcnt(6)
    v_mfma_f32_32x32x16_bf16 v[64:79], v[240:243], a[104:107], v[64:79]
    ds_read_b64_tr_b16 v[236:237], v3 offset:34816
    ds_read_b64_tr_b16 v[238:239], v3 offset:35840
    buffer_load_dwordx4 v10, s[8:11], s44 offen offset:1024 lds
    v_mfma_f32_32x32x16_bf16 v[64:79], v[244:247], a[108:111], v[64:79]
    ds_read_b64_tr_b16 v[240:241], v3 offset:36864
    ds_read_b64_tr_b16 v[242:243], v3 offset:37888
    s_waitcnt lgkmcnt(6)
    v_mfma_f32_32x32x16_bf16 v[80:95], v[224:227], a[104:107], v[80:95]
    ds_read_b64_tr_b16 v[244:245], v3 offset:38912
    ds_read_b64_tr_b16 v[246:247], v3 offset:39936
    buffer_load_dwordx4 v11, s[8:11], s44 offen offset:2048 lds
    v_mfma_f32_32x32x16_bf16 v[80:95], v[228:231], a[108:111], v[80:95]
    ds_read_b64_tr_b16 v[224:225], v3 offset:40960
    ds_read_b64_tr_b16 v[226:227], v3 offset:41984
    s_waitcnt lgkmcnt(6)
    v_mfma_f32_32x32x16_bf16 v[96:111], v[232:235], v[200:203], v[96:111]
    ds_read_b64_tr_b16 v[228:229], v3 offset:43008
    ds_read_b64_tr_b16 v[230:231], v3 offset:44032
    buffer_load_dwordx4 v12, s[8:11], s44 offen offset:3072 lds
    v_mfma_f32_32x32x16_bf16 v[96:111], v[236:239], v[204:207], v[96:111]
    ds_read_b64_tr_b16 v[232:233], v3 offset:45056
    ds_read_b64_tr_b16 v[234:235], v3 offset:46080
    s_waitcnt lgkmcnt(6)
    v_mfma_f32_32x32x16_bf16 v[96:111], v[240:243], a[56:59], v[96:111]
    ds_read_b64_tr_b16 v[236:237], v3 offset:47104
    ds_read_b64_tr_b16 v[238:239], v3 offset:48128
    v_mfma_f32_32x32x16_bf16 v[96:111], v[244:247], a[60:63], v[96:111]
    ds_read_b64_tr_b16 v[240:241], v3 offset:49152
    ds_read_b64_tr_b16 v[242:243], v3 offset:50176
    s_waitcnt lgkmcnt(6)
    v_mfma_f32_32x32x16_bf16 v[96:111], v[224:227], a[64:67], v[96:111]
    ds_read_b64_tr_b16 v[244:245], v3 offset:51200
    ds_read_b64_tr_b16 v[246:247], v3 offset:52224
    v_mfma_f32_32x32x16_bf16 v[96:111], v[228:231], a[68:71], v[96:111]
    s_waitcnt vmcnt(6)
    v_cmp_gt_u32 s[60:61], 2, v15
    s_nop 3
    s_cmp_lg_u64 s[60:61], 0
    s_cbranch_scc1 L_slow7
L_back7:
    ds_read_b64_tr_b16 v[224:225], v3 offset:53248
    ds_read_b64_tr_b16 v[226:227], v3 offset:54272
    s_waitcnt lgkmcnt(6)
    v_mfma_f32_32x32x16_bf16 v[96:111], v[232:235], a[72:75], v[96:111]
    s_add_u32 s50, s35, 25165824
    ds_read_b64_tr_b16 v[228:229], v3 offset:55296
    ds_read_b64_tr_b16 v[230:231], v3 offset:56320
    buffer_load_dwordx4 a[112:115], v2, s[20:23], s50 offen offset:0 sc1
    v_mfma_f32_32x32x16_bf16 v[96:111], v[236:239], a[76:79], v[96:111]
    ds_read_b64_tr_b16 v[232:233], v3 offset:57344
    ds_read_b64_tr_b16 v[234:235], v3 offset:58368
    s_waitcnt lgkmcnt(6)
    v_mfma_f32_32x32x16_bf16 v[96:111], v[240:243], a[80:83], v[96:111]
    ds_read_b64_tr_b16 v[236:237], v3 offset:59392
    ds_read_b64_tr_b16 v[238:239], v3 offset:60416
    buffer_load_dwordx4 a[116:119], v2, s[20:23], s50 offen offset:1024 sc1
    v_mfma_f32_32x32x16_bf16 v[96:111], v[244:247], a[84:87], v[96:111]
    ds_read_b64_tr_b16 v[240:241], v3 offset:61440
    ds_read_b64_tr_b16 v[242:243], v3 offset:62464
    s_waitcnt lgkmcnt(6)
    v_mfma_f32_32x32x16_bf16 v[96:111], v[224:227], a[88:91], v[96:111]
    s_add_u32 s50, s36, 25165824
    ds_read_b64_tr_b16 v[244:245], v3 offset:63488
    ds_read_b64_tr_b16 v[246:247], v3 offset:64512
    buffer_load_dwordx4 a[120:123], v2, s[20:23], s50 offen offset:0 sc1
    v_mfma_f32_32x32x16_bf16 v[96:111], v[228:231], a[92:95], v[96:111]
    ds_read_b64_tr_b16 v[224:225], v4 offset:32768
    ds_read_b64_tr_b16 v[226:227], v4 offset:33792
    s_waitcnt lgkmcnt(6)
    v_mfma_f32_32x32x16_bf16 v[96:111], v[232:235], a[96:99], v[96:111]
    ds_read_b64_tr_b16 v[228:229], v4 offset:34816
    ds_read_b64_tr_b16 v[230:231], v4 offset:35840
    buffer_load_dwordx4 a[124:127], v2, s[20:23], s50 offen offset:1024 sc1
    v_mfma_f32_32x32x16_bf16 v[96:111], v[236:239], a[100:103], v[96:111]
    ds_read_b64_tr_b16 v[232:233], v4 offset:36864
    ds_read_b64_tr_b16 v[234:235], v4 offset:37888
    s_waitcnt lgkmcnt(6)
    v_mfma_f32_32x32x16_bf16 v[96:111], v[240:243], a[104:107], v[96:111]
    s_add_u32 s50, s37, 25165824
    ds_read_b64_tr_b16 v[236:237], v4 offset:38912
    ds_read_b64_tr_b16 v[238:239], v4 offset:39936
    buffer_load_dwordx4 a[128:131], v2, s[20:23], s50 offen offset:0 sc1
    v_mfma_f32_32x32x16_bf16 v[96:111], v[244:247], a[108:111], v[96:111]
    ds_read_b64_tr_b16 v[240:241], v4 offset:40960
    ds_read_b64_tr_b16 v[242:243], v4 offset:41984
    s_waitcnt lgkmcnt(6)
    v_mfma_f32_32x32x16_bf16 v[112:127], v[224:227], v[200:203], v[112:127]
    ds_read_b64_tr_b16 v[244:245], v4 offset:43008
    ds_read_b64_tr_b16 v[246:247], v4 offset:44032
    buffer_load_dwordx4 a[132:135], v2, s[20:23], s50 offen offset:1024 sc1
    v_mfma_f32_32x32x16_bf16 v[112:127], v[228:231], v[204:207], v[112:127]
    s_barrier
    ds_read_b64_tr_b16 v[224:225], v4 offset:45056
    ds_read_b64_tr_b16 v[226:227], v4 offset:46080
    s_waitcnt lgkmcnt(6)
    v_mfma_f32_32x32x16_bf16 v[112:127], v[232:235], a[56:59], v[112:127]
    s_add_u32 s50, s38, 25165824
    ds_read_b64_tr_b16 v[228:229], v4 offset:47104
    ds_read_b64_tr_b16 v[230:231], v4 offset:48128
    buffer_load_dwordx4 a[136:139], v2, s[20:23], s50 offen offset:0 sc1
    v_mfma_f32_32x32x16_bf16 v[112:127], v[236:239], a[60:63], v[112:127]
    ds_read_b64_tr_b16 v[232:233], v4 offset:49152
    ds_read_b64_tr_b16 v[234:235], v4 offset:50176
    s_waitcnt lgkmcnt(6)
    v_mfma_f32_32x32x16_bf16 v[112:127], v[240:243], a[64:67], v[112:127]
    ds_read_b64_tr_b16 v[236:237], v4 offset:51200
    ds_read_b64_tr_b16 v[238:239], v4 offset:52224
    buffer_load_dwordx4 a[140:143], v2, s[20:23], s50 offen offset:1024 sc1
    v_mfma_f32_32x32x16_bf16 v[112:127], v[244:247], a[68:71], v[112:127]
    ds_read_b64_tr_b16 v[240:241], v4 offset:53248
    ds_read_b64_tr_b16 v[242:243], v4 offset:54272
    s_waitcnt lgkmcnt(6)
    v_mfma_f32_32x32x16_bf16 v[112:127], v[224:227], a[72:75], v[112:127]
    s_add_u32 s50, s39, 25165824
    ds_read_b64_tr_b16 v[244:245], v4 offset:55296
    ds_read_b64_tr_b16 v[246:247], v4 offset:56320
    buffer_load_dwordx4 a[144:147], v2, s[20:23], s50 offen offset:0 sc1
    v_mfma_f32_32x32x16_bf16 v[112:127], v[228:231], a[76:79], v[112:127]
    ds_read_b64_tr_b16 v[224:225], v4 offset:57344
    ds_read_b64_tr_b16 v[226:227], v4 offset:58368
    s_waitcnt lgkmcnt(6)
    v_mfma_f32_32x32x16_bf16 v[112:127], v[232:235], a[80:83], v[112:127]
    ds_read_b64_tr_b16 v[228:229], v4 offset:59392
    ds_read_b64_tr_b16 v[230:231], v4 offset:60416
    buffer_load_dwordx4 a[148:151], v2, s[20:23], s50 offen offset:1024 sc1
    v_mfma_f32_32x32x16_bf16 v[112:127], v[236:239], a[84:87], v[112:127]
    ds_read_b64_tr_b16 v[232:233], v4 offset:61440
    ds_read_b64_tr_b16 v[234:235], v4 offset:62464
    s_waitcnt lgkmcnt(6)
    v_mfma_f32_32x32x16_bf16 v[112:127], v[240:243], a[88:91], v[112:127]
    s_add_u32 s50, s40, 25165824
    ds_read_b64_tr_b16 v[236:237], v4 offset:63488
    ds_read_b64_tr_b16 v[238:239], v4 offset:64512
    buffer_load_dwordx4 a[152:155], v2, s[20:23], s50 offen offset:0 sc1
    v_mfma_f32_32x32x16_bf16 v[112:127], v[244:247], a[92:95], v[112:127]
    ds_read_b64_tr_b16 v[240:241], v5 offset:0
    ds_read_b64_tr_b16 v[242:243], v5 offset:1024
    s_waitcnt lgkmcnt(6)
    v_mfma_f32_32x32x16_bf16 v[112:127], v[224:227], a[96:99], v[112:127]
    ds_read_b64_tr_b16 v[244:245], v5 offset:2048
    ds_read_b64_tr_b16 v[246:247], v5 offset:3072
    buffer_load_dwordx4 a[156:159], v2, s[20:23], s50 offen offset:1024 sc1
    v_mfma_f32_32x32x16_bf16 v[112:127], v[228:231], a[100:103], v[112:127]
    ds_read_b64_tr_b16 v[224:225], v6 offset:0
    ds_read_b64_tr_b16 v[226:227], v6 offset:1024
    s_waitcnt lgkmcnt(6)
    v_mfma_f32_32x32x16_bf16 v[112:127], v[232:235], a[104:107], v[112:127]
    s_add_u32 s50, s41, 25165824
    ds_read_b64_tr_b16 v[228:229], v6 offset:2048
    ds_read_b64_tr_b16 v[230:231], v6 offset:3072
    buffer_load_dwordx4 a[160:163], v2, s[20:23], s50 offen offset:0 sc1
    v_mfma_f32_32x32x16_bf16 v[112:127], v[236:239], a[108:111], v[112:127]
    ds_read_b64_tr_b16 v[232:233], v5 offset:4096
    ds_read_b64_tr_b16 v[234:235], v5 offset:5120
    s_waitcnt lgkmcnt(6)
    v_mfma_f32_32x32x16_bf16 v[64:79], v[240:243], v[208:211], v[64:79]
    ds_read_b64_tr_b16 v[236:237], v5 offset:6144
    ds_read_b64_tr_b16 v[238:239], v5 offset:7168
    buffer_load_dwordx4 a[164:167], v2, s[20:23], s50 offen offset:1024 sc1
    v_mfma_f32_32x32x16_bf16 v[64:79], v[244:247], v[212:215], v[64:79]
    ds_read_b64_tr_b16 v[240:241], v6 offset:4096
    ds_read_b64_tr_b16 v[242:243], v6 offset:5120
    s_waitcnt lgkmcnt(6)
    v_mfma_f32_32x32x16_bf16 v[80:95], v[224:227], v[208:211], v[80:95]
    s_add_u32 m0, s42, 0
    s_add_u32 s44, s32, 4391040
    ds_read_b64_tr_b16 v[244:245], v6 offset:6144
    ds_read_b64_tr_b16 v[246:247], v6 offset:7168
    buffer_load_dwordx4 v9, s[8:11], s44 offen lds
    v_mfma_f32_32x32x16_bf16 v[80:95], v[228:231], v[212:215], v[80:95]
    ds_read_b64_tr_b16 v[224:225], v5 offset:8192
    ds_read_b64_tr_b16 v[226:227], v5 offset:9216
    s_waitcnt vmcnt(13) lgkmcnt(6)
    v_mfma_f32_32x32x16_bf16 v[64:79], v[232:235], a[112:115], v[64:79]
    ds_read_b64_tr_b16 v[228:229], v5 offset:10240
    ds_read_b64_tr_b16 v[230:231], v5 offset:11264
    buffer_load_dwordx4 v10, s[8:11], s44 offen offset:1024 lds
    v_mfma_f32_32x32x16_bf16 v[64:79], v[236:239], a[116:119], v[64:79]
    ds_read_b64_tr_b16 v[232:233], v6 offset:8192
    ds_read_b64_tr_b16 v[234:235], v6 offset:9216
    s_waitcnt lgkmcnt(6)
    v_mfma_f32_32x32x16_bf16 v[80:95], v[240:243], a[112:115], v[80:95]
    ds_read_b64_tr_b16 v[236:237], v6 offset:10240
    ds_read_b64_tr_b16 v[238:239], v6 offset:11264
    buffer_load_dwordx4 v11, s[8:11], s44 offen offset:2048 lds
    v_mfma_f32_32x32x16_bf16 v[80:95], v[244:247], a[116:119], v[80:95]
    ds_read_b64_tr_b16 v[240:241], v5 offset:12288
    ds_read_b64_tr_b16 v[242:243], v5 offset:13312
    s_waitcnt vmcnt(13) lgkmcnt(6)
    v_mfma_f32_32x32x16_bf16 v[64:79], v[224:227], a[120:123], v[64:79]
    ds_read_b64_tr_b16 v[244:245], v5 offset:14336
    ds_read_b64_tr_b16 v[246:247], v5 offset:15360
    buffer_load_dwordx4 v12, s[8:11], s44 offen offset:3072 lds
    v_mfma_f32_32x32x16_bf16 v[64:79], v[228:231], a[124:127], v[64:79]
    ds_read_b64_tr_b16 v[224:225], v6 offset:12288
    ds_read_b64_tr_b16 v[226:227], v6 offset:13312
    s_waitcnt lgkmcnt(6)
    v_mfma_f32_32x32x16_bf16 v[80:95], v[232:235], a[120:123], v[80:95]
    s_add_u32 m0, s42, 4096
    s_add_u32 s44, s33, 4391040
    ds_read_b64_tr_b16 v[228:229], v6 offset:14336
    ds_read_b64_tr_b16 v[230:231], v6 offset:15360
    buffer_load_dwordx4 v9, s[8:11], s44 offen lds
    v_mfma_f32_32x32x16_bf16 v[80:95], v[236:239], a[124:127], v[80:95]
    ds_read_b64_tr_b16 v[232:233], v5 offset:16384
    ds_read_b64_tr_b16 v[234:235], v5 offset:17408
    s_waitcnt vmcnt(13) lgkmcnt(6)
    v_mfma_f32_32x32x16_bf16 v[64:79], v[240:243], a[128:131], v[64:79]
    ds_read_b64_tr_b16 v[236:237], v5 offset:18432
    ds_read_b64_tr_b16 v[238:239], v5 offset:19456
    buffer_load_dwordx4 v10, s[8:11], s44 offen offset:1024 lds
    v_mfma_f32_32x32x16_bf16 v[64:79], v[244:247], a[132:135], v[64:79]
    ds_read_b64_tr_b16 v[240:241], v6 offset:16384
    ds_read_b64_tr_b16 v[242:243], v6 offset:17408
    s_waitcnt lgkmcnt(6)
    v_mfma_f32_32x32x16_bf16 v[80:95], v[224:227], a[128:131], v[80:95]
    ds_read_b64_tr_b16 v[244:245], v6 offset:18432
    ds_read_b64_tr_b16 v[246:247], v6 offset:19456
    buffer_load_dwordx4 v11, s[8:11], s44 offen offset:2048 lds
    v_mfma_f32_32x32x16_bf16 v[80:95], v[228:231], a[132:135], v[80:95]
    ds_read_b64_tr_b16 v[224:225], v5 offset:20480
    ds_read_b64_tr_b16 v[226:227], v5 offset:21504
    s_waitcnt vmcnt(13) lgkmcnt(6)
    v_mfma_f32_32x32x16_bf16 v[64:79], v[232:235], a[136:139], v[64:79]
    ds_read_b64_tr_b16 v[228:229], v5 offset:22528
    ds_read_b64_tr_b16 v[230:231], v5 offset:23552
    buffer_load_dwordx4 v12, s[8:11], s44 offen offset:3072 lds
    v_mfma_f32_32x32x16_bf16 v[64:79], v[236:239], a[140:143], v[64:79]
    s_barrier
    ds_read_b64_tr_b16 v[232:233], v6 offset:20480
    ds_read_b64_tr_b16 v[234:235], v6 offset:21504
    s_waitcnt lgkmcnt(6)
    v_mfma_f32_32x32x16_bf16 v[80:95], v[240:243], a[136:139], v[80:95]
    ds_read_b64_tr_b16 v[236:237], v6 offset:22528
    ds_read_b64_tr_b16 v[238:239], v6 offset:23552
    v_mfma_f32_32x32x16_bf16 v[80:95], v[244:247], a[140:143], v[80:95]
    ds_read_b64_tr_b16 v[240:241], v5 offset:24576
    ds_read_b64_tr_b16 v[242:243], v5 offset:25600
    s_waitcnt vmcnt(12) lgkmcnt(6)
    v_mfma_f32_32x32x16_bf16 v[64:79], v[224:227], a[144:147], v[64:79]
    ds_read_b64_tr_b16 v[244:245], v5 offset:26624
    ds_read_b64_tr_b16 v[246:247], v5 offset:27648
    v_mfma_f32_32x32x16_bf16 v[64:79], v[228:231], a[148:151], v[64:79]
    buffer_load_dword v15, v14, s[20:23], 0 offen offset:96 sc1
    ds_read_b64_tr_b16 v[224:225], v6 offset:24576
    ds_read_b64_tr_b16 v[226:227], v6 offset:25600
    s_waitcnt lgkmcnt(6)
    v_mfma_f32_32x32x16_bf16 v[80:95], v[232:235], a[144:147], v[80:95]
    ds_read_b64_tr_b16 v[228:229], v6 offset:26624
    ds_read_b64_tr_b16 v[230:231], v6 offset:27648
    v_mfma_f32_32x32x16_bf16 v[80:95], v[236:239], a[148:151], v[80:95]
    ds_read_b64_tr_b16 v[232:233], v5 offset:28672
    ds_read_b64_tr_b16 v[234:235], v5 offset:29696
    s_waitcnt vmcnt(11) lgkmcnt(6)
    v_mfma_f32_32x32x16_bf16 v[64:79], v[240:243], a[152:155], v[64:79]
    ds_read_b64_tr_b16 v[236:237], v5 offset:30720
    ds_read_b64_tr_b16 v[238:239], v5 offset:31744
    v_mfma_f32_32x32x16_bf16 v[64:79], v[244:247], a[156:159], v[64:79]
    ds_read_b64_tr_b16 v[240:241], v6 offset:28672
    ds_read_b64_tr_b16 v[242:243], v6 offset:29696
    s_waitcnt lgkmcnt(6)
    v_mfma_f32_32x32x16_bf16 v[80:95], v[224:227], a[152:155], v[80:95]
    ds_read_b64_tr_b16 v[244:245], v6 offset:30720
    ds_read_b64_tr_b16 v[246:247], v6 offset:31744
    v_mfma_f32_32x32x16_bf16 v[80:95], v[228:231], a[156:159], v[80:95]
    ds_read_b64_tr_b16 v[224:225], v5 offset:32768
    ds_read_b64_tr_b16 v[226:227], v5 offset:33792
    s_waitcnt vmcnt(9) lgkmcnt(6)
    v_mfma_f32_32x32x16_bf16 v[64:79], v[232:235], a[160:163], v[64:79]
    ds_read_b64_tr_b16 v[228:229], v5 offset:34816
    ds_read_b64_tr_b16 v[230:231], v5 offset:35840
    v_mfma_f32_32x32x16_bf16 v[64:79], v[236:239], a[164:167], v[64:79]
    ds_read_b64_tr_b16 v[232:233], v5 offset:36864
    ds_read_b64_tr_b16 v[234:235], v5 offset:37888
    s_waitcnt lgkmcnt(6)
    v_mfma_f32_32x32x16_bf16 v[80:95], v[240:243], a[160:163], v[80:95]
    ds_read_b64_tr_b16 v[236:237], v5 offset:38912
    ds_read_b64_tr_b16 v[238:239], v5 offset:39936
    v_mfma_f32_32x32x16_bf16 v[80:95], v[244:247], a[164:167], v[80:95]
    ds_read_b64_tr_b16 v[240:241], v5 offset:40960
    ds_read_b64_tr_b16 v[242:243], v5 offset:41984
    s_waitcnt lgkmcnt(6)
    v_mfma_f32_32x32x16_bf16 v[96:111], v[224:227], v[208:211], v[96:111]
    ds_read_b64_tr_b16 v[244:245], v5 offset:43008
    ds_read_b64_tr_b16 v[246:247], v5 offset:44032
    v_mfma_f32_32x32x16_bf16 v[96:111], v[228:231], v[212:215], v[96:111]
    ds_read_b64_tr_b16 v[224:225], v5 offset:45056
    ds_read_b64_tr_b16 v[226:227], v5 offset:46080
    s_waitcnt lgkmcnt(6)
    v_mfma_f32_32x32x16_bf16 v[96:111], v[232:235], a[112:115], v[96:111]
    ds_read_b64_tr_b16 v[228:229], v5 offset:47104
    ds_read_b64_tr_b16 v[230:231], v5 offset:48128
    v_mfma_f32_32x32x16_bf16 v[96:111], v[236:239], a[116:119], v[96:111]
    ds_read_b64_tr_b16 v[232:233], v5 offset:49152
    ds_read_b64_tr_b16 v[234:235], v5 offset:50176
    s_waitcnt lgkmcnt(6)
    v_mfma_f32_32x32x16_bf16 v[96:111], v[240:243], a[120:123], v[96:111]
    ds_read_b64_tr_b16 v[236:237], v5 offset:51200
    ds_read_b64_tr_b16 v[238:239], v5 offset:52224
    v_mfma_f32_32x32x16_bf16 v[96:111], v[244:247], a[124:127], v[96:111]
    s_waitcnt vmcnt(0)
    v_cmp_gt_u32 s[60:61], 2, v15
    s_nop 3
    s_cmp_lg_u64 s[60:61], 0
    s_cbranch_scc1 L_slow8
L_back8:
    ds_read_b64_tr_b16 v[240:241], v5 offset:53248
    ds_read_b64_tr_b16 v[242:243], v5 offset:54272
    s_waitcnt lgkmcnt(6)
    v_mfma_f32_32x32x16_bf16 v[96:111], v[224:227], a[128:131], v[96:111]
    s_add_u32 s50, s35, 25165824
    ds_read_b64_tr_b16 v[244:245], v5 offset:55296
    ds_read_b64_tr_b16 v[246:247], v5 offset:56320
    buffer_load_dwordx4 a[168:171], v2, s[20:23], s50 offen offset:2048 sc1
    v_mfma_f32_32x32x16_bf16 v[96:111], v[228:231], a[132:135], v[96:111]
    ds_read_b64_tr_b16 v[224:225], v5 offset:57344
    ds_read_b64_tr_b16 v[226:227], v5 offset:58368
    s_waitcnt lgkmcnt(6)
    v_mfma_f32_32x32x16_bf16 v[96:111], v[232:235], a[136:139], v[96:111]
    ds_read_b64_tr_b16 v[228:229], v5 offset:59392
    ds_read_b64_tr_b16 v[230:231], v5 offset:60416
    buffer_load_dwordx4 a[172:175], v2, s[20:23], s50 offen offset:3072 sc1
    v_mfma_f32_32x32x16_bf16 v[96:111], v[236:239], a[140:143], v[96:111]
    ds_read_b64_tr_b16 v[232:233], v5 offset:61440
    ds_read_b64_tr_b16 v[234:235], v5 offset:62464
    s_waitcnt lgkmcnt(6)
    v_mfma_f32_32x32x16_bf16 v[96:111], v[240:243], a[144:147], v[96:111]
    s_add_u32 s50, s36, 25165824
    ds_read_b64_tr_b16 v[236:237], v5 offset:63488
    ds_read_b64_tr_b16 v[238:239], v5 offset:64512
    buffer_load_dwordx4 a[176:179], v2, s[20:23], s50 offen offset:2048 sc1
    v_mfma_f32_32x32x16_bf16 v[96:111], v[244:247], a[148:151], v[96:111]
    ds_read_b64_tr_b16 v[240:241], v6 offset:32768
    ds_read_b64_tr_b16 v[242:243], v6 offset:33792
    s_waitcnt lgkmcnt(6)
    v_mfma_f32_32x32x16_bf16 v[96:111], v[224:227], a[152:155], v[96:111]
    ds_read_b64_tr_b16 v[244:245], v6 offset:34816
    ds_read_b64_tr_b16 v[246:247], v6 offset:35840
    buffer_load_dwordx4 a[180:183], v2, s[20:23], s50 offen offset:3072 sc1
    v_mfma_f32_32x32x16_bf16 v[96:111], v[228:231], a[156:159], v[96:111]
    ds_read_b64_tr_b16 v[224:225], v6 offset:36864
    ds_read_b64_tr_b16 v[226:227], v6 offset:37888
    s_waitcnt lgkmcnt(6)
    v_mfma_f32_32x32x16_bf16 v[96:111], v[232:235], a[160:163], v[96:111]
    s_add_u32 s50, s37, 25165824
    ds_read_b64_tr_b16 v[228:229], v6 offset:38912
    ds_read_b64_tr_b16 v[230:231], v6 offset:39936
    buffer_load_dwordx4 a[184:187], v2, s[20:23], s50 offen offset:2048 sc1
    v_mfma_f32_32x32x16_bf16 v[96:111], v[236:239], a[164:167], v[96:111]
    ds_read_b64_tr_b16 v[232:233], v6 offset:40960
    ds_read_b64_tr_b16 v[234:235], v6 offset:41984
    s_waitcnt lgkmcnt(6)
    v_mfma_f32_32x32x16_bf16 v[112:127], v[240:243], v[208:211], v[112:127]
    ds_read_b64_tr_b16 v[236:237], v6 offset:43008
    ds_read_b64_tr_b16 v[238:239], v6 offset:44032
    buffer_load_dwordx4 a[188:191], v2, s[20:23], s50 offen offset:3072 sc1
    v_mfma_f32_32x32x16_bf16 v[112:127], v[244:247], v[212:215], v[112:127]
    s_barrier
    ds_read_b64_tr_b16 v[240:241], v6 offset:45056
    ds_read_b64_tr_b16 v[242:243], v6 offset:46080
    s_waitcnt lgkmcnt(6)
    v_mfma_f32_32x32x16_bf16 v[112:127], v[224:227], a[112:115], v[112:127]
    s_add_u32 s50, s38, 25165824
    ds_read_b64_tr_b16 v[244:245], v6 offset:47104
    ds_read_b64_tr_b16 v[246:247], v6 offset:48128
    buffer_load_dwordx4 a[192:195], v2, s[20:23], s50 offen offset:2048 sc1
    v_mfma_f32_32x32x16_bf16 v[112:127], v[228:231], a[116:119], v[112:127]
    ds_read_b64_tr_b16 v[224:225], v6 offset:49152
    ds_read_b64_tr_b16 v[226:227], v6 offset:50176
    s_waitcnt lgkmcnt(6)
    v_mfma_f32_32x32x16_bf16 v[112:127], v[232:235], a[120:123], v[112:127]
    ds_read_b64_tr_b16 v[228:229], v6 offset:51200
    ds_read_b64_tr_b16 v[230:231], v6 offset:52224
    buffer_load_dwordx4 a[196:199], v2, s[20:23], s50 offen offset:3072 sc1
    v_mfma_f32_32x32x16_bf16 v[112:127], v[236:239], a[124:127], v[112:127]
    ds_read_b64_tr_b16 v[232:233], v6 offset:53248
    ds_read_b64_tr_b16 v[234:235], v6 offset:54272
    s_waitcnt lgkmcnt(6)
    v_mfma_f32_32x32x16_bf16 v[112:127], v[240:243], a[128:131], v[112:127]
    s_add_u32 s50, s39, 25165824
    ds_read_b64_tr_b16 v[236:237], v6 offset:55296
    ds_read_b64_tr_b16 v[238:239], v6 offset:56320
    buffer_load_dwordx4 a[200:203], v2, s[20:23], s50 offen offset:2048 sc1
    v_mfma_f32_32x32x16_bf16 v[112:127], v[244:247], a[132:135], v[112:127]
    ds_read_b64_tr_b16 v[240:241], v6 offset:57344
    ds_read_b64_tr_b16 v[242:243], v6 offset:58368
    s_waitcnt lgkmcnt(6)
    v_mfma_f32_32x32x16_bf16 v[112:127], v[224:227], a[136:139], v[112:127]
    ds_read_b64_tr_b16 v[244:245], v6 offset:59392
    ds_read_b64_tr_b16 v[246:247], v6 offset:60416
    buffer_load_dwordx4 a[204:207], v2, s[20:23], s50 offen offset:3072 sc1
    v_mfma_f32_32x32x16_bf16 v[112:127], v[228:231], a[140:143], v[112:127]
    ds_read_b64_tr_b16 v[224:225], v6 offset:61440
    ds_read_b64_tr_b16 v[226:227], v6 offset:62464
    s_waitcnt lgkmcnt(6)
    v_mfma_f32_32x32x16_bf16 v[112:127], v[232:235], a[144:147], v[112:127]
    s_add_u32 s50, s40, 25165824
    ds_read_b64_tr_b16 v[228:229], v6 offset:63488
    ds_read_b64_tr_b16 v[230:231], v6 offset:64512
    buffer_load_dwordx4 a[208:211], v2, s[20:23], s50 offen offset:2048 sc1
    v_mfma_f32_32x32x16_bf16 v[112:127], v[236:239], a[148:151], v[112:127]
    ds_read_b64_tr_b16 v[232:233], v7 offset:0
    ds_read_b64_tr_b16 v[234:235], v7 offset:1024
    s_waitcnt lgkmcnt(6)
    v_mfma_f32_32x32x16_bf16 v[112:127], v[240:243], a[152:155], v[112:127]
    ds_read_b64_tr_b16 v[236:237], v7 offset:2048
    ds_read_b64_tr_b16 v[238:239], v7 offset:3072
    buffer_load_dwordx4 a[212:215], v2, s[20:23], s50 offen offset:3072 sc1
    v_mfma_f32_32x32x16_bf16 v[112:127], v[244:247], a[156:159], v[112:127]
    ds_read_b64_tr_b16 v[240:241], v8 offset:0
    ds_read_b64_tr_b16 v[242:243], v8 offset:1024
    s_waitcnt lgkmcnt(6)
    v_mfma_f32_32x32x16_bf16 v[112:127], v[224:227], a[160:163], v[112:127]
    s_add_u32 s50, s41, 25165824
    ds_read_b64_tr_b16 v[244:245], v8 offset:2048
    ds_read_b64_tr_b16 v[246:247], v8 offset:3072
    buffer_load_dwordx4 a[216:219], v2, s[20:23], s50 offen offset:2048 sc1
    v_mfma_f32_32x32x16_bf16 v[112:127], v[228:231], a[164:167], v[112:127]
    ds_read_b64_tr_b16 v[224:225], v7 offset:4096
    ds_read_b64_tr_b16 v[226:227], v7 offset:5120
    s_waitcnt lgkmcnt(6)
    v_mfma_f32_32x32x16_bf16 v[64:79], v[232:235], v[216:219], v[64:79]
    ds_read_b64_tr_b16 v[228:229], v7 offset:6144
    ds_read_b64_tr_b16 v[230:231], v7 offset:7168
    buffer_load_dwordx4 a[220:223], v2, s[20:23], s50 offen offset:3072 sc1
    v_mfma_f32_32x32x16_bf16 v[64:79], v[236:239], v[220:223], v[64:79]
    ds_read_b64_tr_b16 v[232:233], v8 offset:4096
    ds_read_b64_tr_b16 v[234:235], v8 offset:5120
    s_waitcnt lgkmcnt(6)
    v_mfma_f32_32x32x16_bf16 v[80:95], v[240:243], v[216:219], v[80:95]
    ds_read_b64_tr_b16 v[236:237], v8 offset:6144
    ds_read_b64_tr_b16 v[238:239], v8 offset:7168
    v_mfma_f32_32x32x16_bf16 v[80:95], v[244:247], v[220:223], v[80:95]
    ds_read_b64_tr_b16 v[240:241], v7 offset:8192
    ds_read_b64_tr_b16 v[242:243], v7 offset:9216
    s_waitcnt vmcnt(12) lgkmcnt(6)
    v_mfma_f32_32x32x16_bf16 v[64:79], v[224:227], a[168:171], v[64:79]
    ds_read_b64_tr_b16 v[244:245], v7 offset:10240
    ds_read_b64_tr_b16 v[246:247], v7 offset:11264
    v_mfma_f32_32x32x16_bf16 v[64:79], v[228:231], a[172:175], v[64:79]
    ds_read_b64_tr_b16 v[224:225], v8 offset:8192
    ds_read_b64_tr_b16 v[226:227], v8 offset:9216
    s_waitcnt lgkmcnt(6)
    v_mfma_f32_32x32x16_bf16 v[80:95], v[232:235], a[168:171], v[80:95]
    ds_read_b64_tr_b16 v[228:229], v8 offset:10240
    ds_read_b64_tr_b16 v[230:231], v8 offset:11264
    v_mfma_f32_32x32x16_bf16 v[80:95], v[236:239], a[172:175], v[80:95]
    ds_read_b64_tr_b16 v[232:233], v7 offset:12288
    ds_read_b64_tr_b16 v[234:235], v7 offset:13312
    s_waitcnt vmcnt(10) lgkmcnt(6)
    v_mfma_f32_32x32x16_bf16 v[64:79], v[240:243], a[176:179], v[64:79]
    ds_read_b64_tr_b16 v[236:237], v7 offset:14336
    ds_read_b64_tr_b16 v[238:239], v7 offset:15360
    v_mfma_f32_32x32x16_bf16 v[64:79], v[244:247], a[180:183], v[64:79]
    ds_read_b64_tr_b16 v[240:241], v8 offset:12288
    ds_read_b64_tr_b16 v[242:243], v8 offset:13312
    s_waitcnt lgkmcnt(6)
    v_mfma_f32_32x32x16_bf16 v[80:95], v[224:227], a[176:179], v[80:95]
    ds_read_b64_tr_b16 v[244:245], v8 offset:14336
    ds_read_b64_tr_b16 v[246:247], v8 offset:15360
    v_mfma_f32_32x32x16_bf16 v[80:95], v[228:231], a[180:183], v[80:95]
    ds_read_b64_tr_b16 v[224:225], v7 offset:16384
    ds_read_b64_tr_b16 v[226:227], v7 offset:17408
    s_waitcnt vmcnt(8) lgkmcnt(6)
    v_mfma_f32_32x32x16_bf16 v[64:79], v[232:235], a[184:187], v[64:79]
    ds_read_b64_tr_b16 v[228:229], v7 offset:18432
    ds_read_b64_tr_b16 v[230:231], v7 offset:19456
    v_mfma_f32_32x32x16_bf16 v[64:79], v[236:239], a[188:191], v[64:79]
    ds_read_b64_tr_b16 v[232:233], v8 offset:16384
    ds_read_b64_tr_b16 v[234:235], v8 offset:17408
    s_waitcnt lgkmcnt(6)
    v_mfma_f32_32x32x16_bf16 v[80:95], v[240:243], a[184:187], v[80:95]
    ds_read_b64_tr_b16 v[236:237], v8 offset:18432
    ds_read_b64_tr_b16 v[238:239], v8 offset:19456
    v_mfma_f32_32x32x16_bf16 v[80:95], v[244:247], a[188:191], v[80:95]
    ds_read_b64_tr_b16 v[240:241], v7 offset:20480
    ds_read_b64_tr_b16 v[242:243], v7 offset:21504
    s_waitcnt vmcnt(6) lgkmcnt(6)
    v_mfma_f32_32x32x16_bf16 v[64:79], v[224:227], a[192:195], v[64:79]
    ds_read_b64_tr_b16 v[244:245], v7 offset:22528
    ds_read_b64_tr_b16 v[246:247], v7 offset:23552
    v_mfma_f32_32x32x16_bf16 v[64:79], v[228:231], a[196:199], v[64:79]
    s_barrier
    ds_read_b64_tr_b16 v[224:225], v8 offset:20480
    ds_read_b64_tr_b16 v[226:227], v8 offset:21504
    s_waitcnt lgkmcnt(6)
    v_mfma_f32_32x32x16_bf16 v[80:95], v[232:235], a[192:195], v[80:95]
    ds_read_b64_tr_b16 v[228:229], v8 offset:22528
    ds_read_b64_tr_b16 v[230:231], v8 offset:23552
    v_mfma_f32_32x32x16_bf16 v[80:95], v[236:239], a[196:199], v[80:95]
    ds_read_b64_tr_b16 v[232:233], v7 offset:24576
    ds_read_b64_tr_b16 v[234:235], v7 offset:25600
    s_waitcnt vmcnt(4) lgkmcnt(6)
    v_mfma_f32_32x32x16_bf16 v[64:79], v[240:243], a[200:203], v[64:79]
    ds_read_b64_tr_b16 v[236:237], v7 offset:26624
    ds_read_b64_tr_b16 v[238:239], v7 offset:27648
    v_mfma_f32_32x32x16_bf16 v[64:79], v[244:247], a[204:207], v[64:79]
    ds_read_b64_tr_b16 v[240:241], v8 offset:24576
    ds_read_b64_tr_b16 v[242:243], v8 offset:25600
    s_waitcnt lgkmcnt(6)
    v_mfma_f32_32x32x16_bf16 v[80:95], v[224:227], a[200:203], v[80:95]
    ds_read_b64_tr_b16 v[244:245], v8 offset:26624
    ds_read_b64_tr_b16 v[246:247], v8 offset:27648
    v_mfma_f32_32x32x16_bf16 v[80:95], v[228:231], a[204:207], v[80:95]
    ds_read_b64_tr_b16 v[224:225], v7 offset:28672
    ds_read_b64_tr_b16 v[226:227], v7 offset:29696
    s_waitcnt vmcnt(2) lgkmcnt(6)
    v_mfma_f32_32x32x16_bf16 v[64:79], v[232:235], a[208:211], v[64:79]
    ds_read_b64_tr_b16 v[228:229], v7 offset:30720
    ds_read_b64_tr_b16 v[230:231], v7 offset:31744
    v_mfma_f32_32x32x16_bf16 v[64:79], v[236:239], a[212:215], v[64:79]
    ds_read_b64_tr_b16 v[232:233], v8 offset:28672
    ds_read_b64_tr_b16 v[234:235], v8 offset:29696
    s_waitcnt lgkmcnt(6)
    v_mfma_f32_32x32x16_bf16 v[80:95], v[240:243], a[208:211], v[80:95]
    ds_read_b64_tr_b16 v[236:237], v8 offset:30720
    ds_read_b64_tr_b16 v[238:239], v8 offset:31744
    v_mfma_f32_32x32x16_bf16 v[80:95], v[244:247], a[212:215], v[80:95]
    ds_read_b64_tr_b16 v[240:241], v3 offset:0
    ds_read_b64_tr_b16 v[242:243], v3 offset:1024
    s_waitcnt vmcnt(0) lgkmcnt(6)
    v_mfma_f32_32x32x16_bf16 v[64:79], v[224:227], a[216:219], v[64:79]
    ds_read_b64_tr_b16 v[244:245], v3 offset:2048
    ds_read_b64_tr_b16 v[246:247], v3 offset:3072
    v_mfma_f32_32x32x16_bf16 v[64:79], v[228:231], a[220:223], v[64:79]
    ds_read_b64_tr_b16 v[224:225], v3 offset:4096
    ds_read_b64_tr_b16 v[226:227], v3 offset:5120
    s_waitcnt lgkmcnt(6)
    v_mfma_f32_32x32x16_bf16 v[80:95], v[232:235], a[216:219], v[80:95]
    ds_read_b64_tr_b16 v[228:229], v3 offset:6144
    ds_read_b64_tr_b16 v[230:231], v3 offset:7168
    v_mfma_f32_32x32x16_bf16 v[80:95], v[236:239], a[220:223], v[80:95]
    ds_read_b64_tr_b16 v[232:233], v3 offset:8192
    ds_read_b64_tr_b16 v[234:235], v3 offset:9216
    s_waitcnt lgkmcnt(6)
    v_mfma_f32_32x32x16_bf16 v[96:111], v[240:243], v[216:219], v[96:111]
    ds_read_b64_tr_b16 v[236:237], v3 offset:10240
    ds_read_b64_tr_b16 v[238:239], v3 offset:11264
    v_mfma_f32_32x32x16_bf16 v[96:111], v[244:247], v[220:223], v[96:111]
    v_lshlrev_b32 v26, 16, v192
    v_and_b32 v27, s58, v192
    v_fma_f32 v26, v128, v64, v26
    v_fma_f32 v27, v129, v65, v27
    ds_read_b64_tr_b16 v[240:241], v3 offset:12288
    ds_read_b64_tr_b16 v[242:243], v3 offset:13312
    s_waitcnt lgkmcnt(6)
    v_mfma_f32_32x32x16_bf16 v[96:111], v[224:227], a[168:171], v[96:111]
    v_cvt_pk_bf16_f32 v192, v26, v27
    v_lshlrev_b32 v28, 16, v193
    v_and_b32 v29, s58, v193
    v_fma_f32 v28, v130, v66, v28
    v_fma_f32 v29, v131, v67, v29
    ds_read_b64_tr_b16 v[244:245], v3 offset:14336
    ds_read_b64_tr_b16 v[246:247], v3 offset:15360
    v_mfma_f32_32x32x16_bf16 v[96:111], v[228:231], a[172:175], v[96:111]
    v_cvt_pk_bf16_f32 v193, v28, v29
    v_lshlrev_b32 v30, 16, v194
    v_and_b32 v31, s58, v194
    v_fma_f32 v30, v132, v68, v30
    ds_read_b64_tr_b16 v[224:225], v3 offset:16384
    ds_read_b64_tr_b16 v[226:227], v3 offset:17408
    s_waitcnt lgkmcnt(6)
    v_mfma_f32_32x32x16_bf16 v[96:111], v[232:235], a[176:179], v[96:111]
    v_fma_f32 v31, v133, v69, v31
    v_cvt_pk_bf16_f32 v194, v30, v31
    v_lshlrev_b32 v32, 16, v195
    v_and_b32 v33, s58, v195
    v_fma_f32 v32, v134, v70, v32
    ds_read_b64_tr_b16 v[228:229], v3 offset:18432
    ds_read_b64_tr_b16 v[230:231], v3 offset:19456
    v_mfma_f32_32x32x16_bf16 v[96:111], v[236:239], a[180:183], v[96:111]
    v_fma_f32 v33, v135, v71, v33
    v_cvt_pk_bf16_f32 v195, v32, v33
    v_lshlrev_b32 v26, 16, v196
    v_and_b32 v27, s58, v196
    ds_read_b64_tr_b16 v[232:233], v3 offset:20480
    ds_read_b64_tr_b16 v[234:235], v3 offset:21504
    s_waitcnt lgkmcnt(6)
    v_mfma_f32_32x32x16_bf16 v[96:111], v[240:243], a[184:187], v[96:111]
    v_fma_f32 v26, v136, v72, v26
    v_fma_f32 v27, v137, v73, v27
    v_cvt_pk_bf16_f32 v196, v26, v27
    v_lshlrev_b32 v28, 16, v197
    v_and_b32 v29, s58, v197
    ds_read_b64_tr_b16 v[236:237], v3 offset:22528
    ds_read_b64_tr_b16 v[238:239], v3 offset:23552
    v_mfma_f32_32x32x16_bf16 v[96:111], v[244:247], a[188:191], v[96:111]
    v_fma_f32 v28, v138, v74, v28
    v_fma_f32 v29, v139, v75, v29
    v_cvt_pk_bf16_f32 v197, v28, v29
    v_lshlrev_b32 v30, 16, v198
    ds_read_b64_tr_b16 v[240:241], v3 offset:24576
    ds_read_b64_tr_b16 v[242:243], v3 offset:25600
    s_waitcnt lgkmcnt(6)
    v_mfma_f32_32x32x16_bf16 v[96:111], v[224:227], a[192:195], v[96:111]
    v_and_b32 v31, s58, v198
    v_fma_f32 v30, v140, v76, v30
    v_fma_f32 v31, v141, v77, v31
    v_cvt_pk_bf16_f32 v198, v30, v31
    v_lshlrev_b32 v32, 16, v199
    ds_read_b64_tr_b16 v[244:245], v3 offset:26624
    ds_read_b64_tr_b16 v[246:247], v3 offset:27648
    v_mfma_f32_32x32x16_bf16 v[96:111], v[228:231], a[196:199], v[96:111]
    v_and_b32 v33, s58, v199
    v_fma_f32 v32, v142, v78, v32
    v_fma_f32 v33, v143, v79, v33
    v_cvt_pk_bf16_f32 v199, v32, v33
    ds_read_b64_tr_b16 v[224:225], v3 offset:28672
    ds_read_b64_tr_b16 v[226:227], v3 offset:29696
    s_waitcnt lgkmcnt(6)
    v_mfma_f32_32x32x16_bf16 v[96:111], v[232:235], a[200:203], v[96:111]
    v_lshlrev_b32 v26, 16, v200
    v_and_b32 v27, s58, v200
    v_fma_f32 v26, v144, v80, v26
    v_fma_f32 v27, v145, v81, v27
    v_cvt_pk_bf16_f32 v200, v26, v27
    ds_read_b64_tr_b16 v[228:229], v3 offset:30720
    ds_read_b64_tr_b16 v[230:231], v3 offset:31744
    v_mfma_f32_32x32x16_bf16 v[96:111], v[236:239], a[204:207], v[96:111]
    s_nop 1
    v_permlane32_swap_b32 v192, v194
    v_permlane32_swap_b32 v193, v195
    s_nop 1
    v_permlane32_swap_b32 v196, v198
    v_permlane32_swap_b32 v197, v199
    ds_read_b64_tr_b16 v[232:233], v4 offset:0
    ds_read_b64_tr_b16 v[234:235], v4 offset:1024
    s_waitcnt lgkmcnt(6)
    v_mfma_f32_32x32x16_bf16 v[96:111], v[240:243], a[208:211], v[96:111]
    buffer_store_dwordx4 v[192:195], v25, s[16:19], s57 offen offset:0
    buffer_store_dwordx4 v[196:199], v25, s[16:19], s57 offen offset:32
    v_lshlrev_b32 v28, 16, v201
    v_and_b32 v29, s58, v201
    v_fma_f32 v28, v146, v82, v28
    ds_read_b64_tr_b16 v[236:237], v4 offset:2048
    ds_read_b64_tr_b16 v[238:239], v4 offset:3072
    v_mfma_f32_32x32x16_bf16 v[96:111], v[244:247], a[212:215], v[96:111]
    v_fma_f32 v29, v147, v83, v29
    v_cvt_pk_bf16_f32 v201, v28, v29
    v_lshlrev_b32 v30, 16, v202
    v_and_b32 v31, s58, v202
    ds_read_b64_tr_b16 v[240:241], v4 offset:4096
    ds_read_b64_tr_b16 v[242:243], v4 offset:5120
    s_waitcnt lgkmcnt(6)
    v_mfma_f32_32x32x16_bf16 v[96:111], v[224:227], a[216:219], v[96:111]
    v_fma_f32 v30, v148, v84, v30
    v_fma_f32 v31, v149, v85, v31
    v_cvt_pk_bf16_f32 v202, v30, v31
    v_lshlrev_b32 v32, 16, v203
    v_and_b32 v33, s58, v203
    ds_read_b64_tr_b16 v[244:245], v4 offset:6144
    ds_read_b64_tr_b16 v[246:247], v4 offset:7168
    v_mfma_f32_32x32x16_bf16 v[96:111], v[228:231], a[220:223], v[96:111]
    v_fma_f32 v32, v150, v86, v32
    v_fma_f32 v33, v151, v87, v33
    v_cvt_pk_bf16_f32 v203, v32, v33
    v_lshlrev_b32 v26, 16, v204
    ds_read_b64_tr_b16 v[224:225], v4 offset:8192
    ds_read_b64_tr_b16 v[226:227], v4 offset:9216
    s_waitcnt lgkmcnt(6)
    v_mfma_f32_32x32x16_bf16 v[112:127], v[232:235], v[216:219], v[112:127]
    v_and_b32 v27, s58, v204
    v_fma_f32 v26, v152, v88, v26
    v_fma_f32 v27, v153, v89, v27
    v_cvt_pk_bf16_f32 v204, v26, v27
    v_lshlrev_b32 v28, 16, v205
    ds_read_b64_tr_b16 v[228:229], v4 offset:10240
    ds_read_b64_tr_b16 v[230:231], v4 offset:11264
    v_mfma_f32_32x32x16_bf16 v[112:127], v[236:239], v[220:223], v[112:127]
    v_and_b32 v29, s58, v205
    v_fma_f32 v28, v154, v90, v28
    v_fma_f32 v29, v155, v91, v29
    v_cvt_pk_bf16_f32 v205, v28, v29
    ds_read_b64_tr_b16 v[232:233], v4 offset:12288
    ds_read_b64_tr_b16 v[234:235], v4 offset:13312
    s_waitcnt lgkmcnt(6)
    v_mfma_f32_32x32x16_bf16 v[112:127], v[240:243], a[168:171], v[112:127]
    v_lshlrev_b32 v30, 16, v206
    v_and_b32 v31, s58, v206
    v_fma_f32 v30, v156, v92, v30
    v_fma_f32 v31, v157, v93, v31
    v_cvt_pk_bf16_f32 v206, v30, v31
    ds_read_b64_tr_b16 v[236:237], v4 offset:14336
    ds_read_b64_tr_b16 v[238:239], v4 offset:15360
    v_mfma_f32_32x32x16_bf16 v[112:127], v[244:247], a[172:175], v[112:127]
    v_lshlrev_b32 v32, 16, v207
    v_and_b32 v33, s58, v207
    v_fma_f32 v32, v158, v94, v32
    v_fma_f32 v33, v159, v95, v33
    ds_read_b64_tr_b16 v[240:241], v4 offset:16384
    ds_read_b64_tr_b16 v[242:243], v4 offset:17408
    s_waitcnt lgkmcnt(6)
    v_mfma_f32_32x32x16_bf16 v[112:127], v[224:227], a[176:179], v[112:127]
    v_cvt_pk_bf16_f32 v207, v32, v33
    ds_read_b64_tr_b16 v[244:245], v4 offset:18432
    ds_read_b64_tr_b16 v[246:247], v4 offset:19456
    v_mfma_f32_32x32x16_bf16 v[112:127], v[228:231], a[180:183], v[112:127]
    v_lshlrev_b32 v26, 16, v208
    v_and_b32 v27, s58, v208
    v_fma_f32 v26, v160, v96, v26
    v_fma_f32 v27, v161, v97, v27
    ds_read_b64_tr_b16 v[224:225], v4 offset:20480
    ds_read_b64_tr_b16 v[226:227], v4 offset:21504
    s_waitcnt lgkmcnt(6)
    v_mfma_f32_32x32x16_bf16 v[112:127], v[232:235], a[184:187], v[112:127]
    s_nop 1
    v_permlane32_swap_b32 v200, v202
    v_permlane32_swap_b32 v201, v203
    s_nop 1
    v_permlane32_swap_b32 v204, v206
    v_permlane32_swap_b32 v205, v207
    ds_read_b64_tr_b16 v[228:229], v4 offset:22528
    ds_read_b64_tr_b16 v[230:231], v4 offset:23552
    v_mfma_f32_32x32x16_bf16 v[112:127], v[236:239], a[188:191], v[112:127]
    buffer_store_dwordx4 v[200:203], v25, s[16:19], s57 offen offset:64
    buffer_store_dwordx4 v[204:207], v25, s[16:19], s57 offen offset:96
    v_cvt_pk_bf16_f32 v208, v26, v27
    v_lshlrev_b32 v28, 16, v209
    ds_read_b64_tr_b16 v[232:233], v4 offset:24576
    ds_read_b64_tr_b16 v[234:235], v4 offset:25600
    s_waitcnt lgkmcnt(6)
    v_mfma_f32_32x32x16_bf16 v[112:127], v[240:243], a[192:195], v[112:127]
    v_and_b32 v29, s58, v209
    v_fma_f32 v28, v162, v98, v28
    v_fma_f32 v29, v163, v99, v29
    v_cvt_pk_bf16_f32 v209, v28, v29
    v_lshlrev_b32 v30, 16, v210
    ds_read_b64_tr_b16 v[236:237], v4 offset:26624
    ds_read_b64_tr_b16 v[238:239], v4 offset:27648
    v_mfma_f32_32x32x16_bf16 v[112:127], v[244:247], a[196:199], v[112:127]
    v_and_b32 v31, s58, v210
    v_fma_f32 v30, v164, v100, v30
    v_fma_f32 v31, v165, v101, v31
    v_cvt_pk_bf16_f32 v210, v30, v31
    ds_read_b64_tr_b16 v[240:241], v4 offset:28672
    ds_read_b64_tr_b16 v[242:243], v4 offset:29696
    s_waitcnt lgkmcnt(6)
    v_mfma_f32_32x32x16_bf16 v[112:127], v[224:227], a[200:203], v[112:127]
    v_lshlrev_b32 v32, 16, v211
    v_and_b32 v33, s58, v211
    v_fma_f32 v32, v166, v102, v32
    v_fma_f32 v33, v167, v103, v33
    v_cvt_pk_bf16_f32 v211, v32, v33
    ds_read_b64_tr_b16 v[244:245], v4 offset:30720
    ds_read_b64_tr_b16 v[246:247], v4 offset:31744
    v_mfma_f32_32x32x16_bf16 v[112:127], v[228:231], a[204:207], v[112:127]
    v_lshlrev_b32 v26, 16, v212
    v_and_b32 v27, s58, v212
    v_fma_f32 v26, v168, v104, v26
    v_fma_f32 v27, v169, v105, v27
    s_waitcnt lgkmcnt(4)
    v_mfma_f32_32x32x16_bf16 v[112:127], v[232:235], a[208:211], v[112:127]
    v_cvt_pk_bf16_f32 v212, v26, v27
    v_lshlrev_b32 v28, 16, v213
    v_and_b32 v29, s58, v213
    v_fma_f32 v28, v170, v106, v28
    v_fma_f32 v29, v171, v107, v29
    v_mfma_f32_32x32x16_bf16 v[112:127], v[236:239], a[212:215], v[112:127]
    v_cvt_pk_bf16_f32 v213, v28, v29
    v_lshlrev_b32 v30, 16, v214
    v_and_b32 v31, s58, v214
    v_fma_f32 v30, v172, v108, v30
    s_waitcnt lgkmcnt(0)
    v_mfma_f32_32x32x16_bf16 v[112:127], v[240:243], a[216:219], v[112:127]
    v_fma_f32 v31, v173, v109, v31
    v_cvt_pk_bf16_f32 v214, v30, v31
    v_lshlrev_b32 v32, 16, v215
    v_and_b32 v33, s58, v215
    v_fma_f32 v32, v174, v110, v32
    v_mfma_f32_32x32x16_bf16 v[112:127], v[244:247], a[220:223], v[112:127]
    s_nop 15
    v_fma_f32 v33, v175, v111, v33
    v_cvt_pk_bf16_f32 v215, v32, v33
    s_nop 1
    v_permlane32_swap_b32 v208, v210
    v_permlane32_swap_b32 v209, v211
    s_nop 1
    v_permlane32_swap_b32 v212, v214
    v_permlane32_swap_b32 v213, v215
    buffer_store_dwordx4 v[208:211], v25, s[16:19], s57 offen offset:128
    buffer_store_dwordx4 v[212:215], v25, s[16:19], s57 offen offset:160
    v_lshlrev_b32 v26, 16, v216
    v_and_b32 v27, s58, v216
    v_fma_f32 v26, v176, v112, v26
    v_fma_f32 v27, v177, v113, v27
    v_cvt_pk_bf16_f32 v216, v26, v27
    v_lshlrev_b32 v28, 16, v217
    v_and_b32 v29, s58, v217
    v_fma_f32 v28, v178, v114, v28
    v_fma_f32 v29, v179, v115, v29
    v_cvt_pk_bf16_f32 v217, v28, v29
    v_lshlrev_b32 v30, 16, v218
    v_and_b32 v31, s58, v218
    v_fma_f32 v30, v180, v116, v30
    v_fma_f32 v31, v181, v117, v31
    v_cvt_pk_bf16_f32 v218, v30, v31
    v_lshlrev_b32 v32, 16, v219
    v_and_b32 v33, s58, v219
    v_fma_f32 v32, v182, v118, v32
    v_fma_f32 v33, v183, v119, v33
    v_cvt_pk_bf16_f32 v219, v32, v33
    v_lshlrev_b32 v26, 16, v220
    v_and_b32 v27, s58, v220
    v_fma_f32 v26, v184, v120, v26
    v_fma_f32 v27, v185, v121, v27
    v_cvt_pk_bf16_f32 v220, v26, v27
    v_lshlrev_b32 v28, 16, v221
    v_and_b32 v29, s58, v221
    v_fma_f32 v28, v186, v122, v28
    v_fma_f32 v29, v187, v123, v29
    v_cvt_pk_bf16_f32 v221, v28, v29
    v_lshlrev_b32 v30, 16, v222
    v_and_b32 v31, s58, v222
    v_fma_f32 v30, v188, v124, v30
    v_fma_f32 v31, v189, v125, v31
    v_cvt_pk_bf16_f32 v222, v30, v31
    v_lshlrev_b32 v32, 16, v223
    v_and_b32 v33, s58, v223
    v_fma_f32 v32, v190, v126, v32
    v_fma_f32 v33, v191, v127, v33
    v_cvt_pk_bf16_f32 v223, v32, v33
    s_nop 1
    v_permlane32_swap_b32 v216, v218
    v_permlane32_swap_b32 v217, v219
    s_nop 1
    v_permlane32_swap_b32 v220, v222
    v_permlane32_swap_b32 v221, v223
    buffer_store_dwordx4 v[216:219], v25, s[16:19], s57 offen offset:192
    buffer_store_dwordx4 v[220:223], v25, s[16:19], s57 offen offset:224
    s_waitcnt vmcnt(0)
L_end:
    s_endpgm
L_rdy_slow:
    s_sub_u32 s74, s74, 1
    s_cbranch_scc1 L_rdy_out
    buffer_load_dword v49, v50, s[24:27], 0 offen sc1
    s_waitcnt vmcnt(0)
    s_branch L_rdy
L_ss0_0:
    buffer_store_dwordx4 v[192:195], v1, s[20:23], s48 offen offset:0 sc1
    buffer_store_dwordx4 v[196:199], v1, s[20:23], s48 offen offset:1024 sc1
    s_branch L_sj0_0
L_ss0_1:
    buffer_store_dwordx4 v[34:37], v1, s[20:23], s48 offen offset:2048 sc1
    buffer_store_dwordx4 v[38:41], v1, s[20:23], s48 offen offset:3072 sc1
    s_branch L_sj0_1
L_fs0_0:
    buffer_store_dword v47, v13, s[20:23], 0 offen offset:0 sc1
    s_branch L_fj0_0
L_fs0_1:
    buffer_store_dword v47, v13, s[20:23], 0 offen offset:32 sc1
    s_branch L_fj0_1
L_slow1:
    buffer_load_dword v15, v14, s[20:23], 0 offen offset:0 sc1
    s_waitcnt vmcnt(0)
    v_cmp_gt_u32 s[60:61], 1, v15
    s_sub_u32 s74, s74, 1
    s_cbranch_scc1 L_back1
    s_nop 1
    s_cmp_lg_u64 s[60:61], 0
    s_cbranch_scc1 L_slow1
    s_branch L_back1
L_ss0_2:
    buffer_store_dwordx4 v[208:211], v2, s[20:23], s48 offen offset:0 sc1
    buffer_store_dwordx4 v[212:215], v2, s[20:23], s48 offen offset:1024 sc1
    s_branch L_sj0_2
L_slow2:
    buffer_load_dword v15, v14, s[20:23], 0 offen offset:32 sc1
    s_waitcnt vmcnt(0)
    v_cmp_gt_u32 s[60:61], 1, v15
    s_sub_u32 s74, s74, 1
    s_cbranch_scc1 L_back2
    s_nop 1
    s_cmp_lg_u64 s[60:61], 0
    s_cbranch_scc1 L_slow2
    s_branch L_back2
L_fs0_2:
    buffer_store_dword v47, v13, s[20:23], 0 offen offset:64 sc1
    s_branch L_fj0_2
L_ss0_3:
    buffer_store_dwordx4 v[216:219], v2, s[20:23], s48 offen offset:2048 sc1
    buffer_store_dwordx4 v[220:223], v2, s[20:23], s48 offen offset:3072 sc1
    s_branch L_sj0_3
L_fs0_3:
    buffer_store_dword v47, v13, s[20:23], 0 offen offset:96 sc1
    s_branch L_fj0_3
L_slow3:
    buffer_load_dword v15, v14, s[20:23], 0 offen offset:64 sc1
    s_waitcnt vmcnt(0)
    v_cmp_gt_u32 s[60:61], 1, v15
    s_sub_u32 s74, s74, 1
    s_cbranch_scc1 L_back3
    s_nop 1
    s_cmp_lg_u64 s[60:61], 0
    s_cbranch_scc1 L_slow3
    s_branch L_back3
L_slow4:
    buffer_load_dword v15, v14, s[20:23], 0 offen offset:96 sc1
    s_waitcnt vmcnt(0)
    v_cmp_gt_u32 s[60:61], 1, v15
    s_sub_u32 s74, s74, 1
    s_cbranch_scc1 L_back4
    s_nop 1
    s_cmp_lg_u64 s[60:61], 0
    s_cbranch_scc1 L_slow4
    s_branch L_back4
L_ss1_0:
    buffer_store_dwordx4 v[192:195], v1, s[20:23], s48 offen offset:0 sc1
    buffer_store_dwordx4 v[196:199], v1, s[20:23], s48 offen offset:1024 sc1
    s_branch L_sj1_0
L_fs1_0:
    buffer_store_dword v47, v13, s[20:23], 0 offen offset:0 sc1
    s_branch L_fj1_0
L_ss1_1:
    buffer_store_dwordx4 v[200:203], v1, s[20:23], s48 offen offset:2048 sc1
    buffer_store_dwordx4 v[204:207], v1, s[20:23], s48 offen offset:3072 sc1
    s_branch L_sj1_1
L_fs1_1:
    buffer_store_dword v47, v13, s[20:23], 0 offen offset:32 sc1
    s_branch L_fj1_1
L_slow5:
    buffer_load_dword v15, v14, s[20:23], 0 offen offset:0 sc1
    s_waitcnt vmcnt(0)
    v_cmp_gt_u32 s[60:61], 2, v15
    s_sub_u32 s74, s74, 1
    s_cbranch_scc1 L_back5
    s_nop 1
    s_cmp_lg_u64 s[60:61], 0
    s_cbranch_scc1 L_slow5
    s_branch L_back5
L_ss1_2:
    buffer_store_dwordx4 v[208:211], v2, s[20:23], s48 offen offset:0 sc1
    buffer_store_dwordx4 v[212:215], v2, s[20:23], s48 offen offset:1024 sc1
    s_branch L_sj1_2
L_fs1_2:
    buffer_store_dword v47, v13, s[20:23], 0 offen offset:64 sc1
    s_branch L_fj1_2
L_ss1_3:
    buffer_store_dwordx4 v[216:219], v2, s[20:23], s48 offen offset:2048 sc1
    buffer_store_dwordx4 v[220:223], v2, s[20:23], s48 offen offset:3072 sc1
    s_branch L_sj1_3
L_slow6:
    buffer_load_dword v15, v14, s[20:23], 0 offen offset:32 sc1
    s_waitcnt vmcnt(0)
    v_cmp_gt_u32 s[60:61], 2, v15
    s_sub_u32 s74, s74, 1
    s_cbranch_scc1 L_back6
    s_nop 1
    s_cmp_lg_u64 s[60:61], 0
    s_cbranch_scc1 L_slow6
    s_branch L_back6
L_fs1_3:
    buffer_store_dword v47, v13, s[20:23], 0 offen offset:96 sc1
    s_branch L_fj1_3
L_slow7:
    buffer_load_dword v15, v14, s[20:23], 0 offen offset:64 sc1
    s_waitcnt vmcnt(0)
    v_cmp_gt_u32 s[60:61], 2, v15
    s_sub_u32 s74, s74, 1
    s_cbranch_scc1 L_back7
    s_nop 1
    s_cmp_lg_u64 s[60:61], 0
    s_cbranch_scc1 L_slow7
    s_branch L_back7
L_slow8:
    buffer_load_dword v15, v14, s[20:23], 0 offen offset:96 sc1
    s_waitcnt vmcnt(0)
    v_cmp_gt_u32 s[60:61], 2, v15
    s_sub_u32 s74, s74, 1
    s_cbranch_scc1 L_back8
    s_nop 1
    s_cmp_lg_u64 s[60:61], 0
    s_cbranch_scc1 L_slow8
    s_branch L_back8
L_codeend:
.section .rodata,"a"
.p2align 6
.amdhsa_kernel standalone__dcn_v2_cross__recsys_kernel
  .amdhsa_next_free_vgpr 512
  .amdhsa_next_free_sgpr 102
  .amdhsa_accum_offset 256
  .amdhsa_group_segment_fixed_size 0
  .amdhsa_kernarg_size 48
  .amdhsa_user_sgpr_count 2
  .amdhsa_user_sgpr_kernarg_segment_ptr 1
  .amdhsa_system_sgpr_workgroup_id_x 1
.end_amdhsa_kernel
```
